```python
import torch

def _softmax(x, axis=-1):
    return torch.softmax(x, dim=axis)

def _gelu(x):
    return torch.nn.functional.gelu(x, approximate='tanh')

def _silu(x):
    return torch.nn.functional.silu(x)

def _sigmoid(x):
    return torch.sigmoid(x)

def _layernorm(x, axis=-1, eps=1e-05):
    m = x.mean(dim=axis, keepdim=True)
    v = x.var(dim=axis, keepdim=True, unbiased=False)
    return (x - m) / torch.sqrt(v + eps)

def _scatter_add(tgt, idx, src, axis=0):
    return tgt.clone().index_add_(axis, idx, src)

def _segment_sum(src, seg, n):
    out = torch.zeros((n,) + src.shape[1:], dtype=src.dtype)
    return out.index_add_(0, seg, src)

def _pad(x, pw):
    flat = tuple((v for pair in reversed(pw) for v in pair))
    return torch.nn.functional.pad(x, flat)
kernel_name = 'adaLN_cond__mha_block_cached__glu_gated_swiglu__decode'

def setup_inputs():

    _w = lambda a: (lambda t: t.to(torch.bfloat16) if t.is_floating_point() else t)(torch.as_tensor(a))

    def _A_setup():
        B, Sq, D = (1, 1, 512)
        H, Sk, Dh = (32, 65536, 128)
        return {'x': _w((lambda *s: torch.randn(*s, dtype=torch.bfloat16) * 0.1)(B, Sq, D)), 'k_cache': _w((lambda *s: torch.randn(*s, dtype=torch.bfloat16) * 1.6)(B, H, Sk, Dh)), 'v_cache': _w((lambda *s: torch.randn(*s, dtype=torch.bfloat16) * 3.2)(B, H, Sk, Dh)), 'wq': _w((lambda *s: torch.randn(*s, dtype=torch.bfloat16) * 1.6)(D, H * Dh) * D ** (-0.5)), 'wo': _w((lambda *s: torch.randn(*s, dtype=torch.bfloat16) * 3.2)(H * Dh, D) * (H * Dh) ** (-0.5))}
    _A_in = _A_setup()

    def _B_setup():
        B, S, D, F = (1, 1, 512, 1792)
        return {'x': _w((lambda *s: torch.randn(*s, dtype=torch.bfloat16) * 0.1)(B, S, D)), 'w1': _w((lambda *s: torch.randn(*s, dtype=torch.bfloat16) * 3.2)(D, F) * (2.0 / D) ** 0.5), 'w3': _w((lambda *s: torch.randn(*s, dtype=torch.bfloat16) * 3.2)(D, F) * (2.0 / D) ** 0.5), 'w2': _w((lambda *s: torch.randn(*s, dtype=torch.bfloat16) * 3.2)(F, D) * (2.0 / F) ** 0.5)}
    _B_in = _B_setup()
    return {'A_x': _A_in['x'], 'A_k_cache': _A_in['k_cache'], 'A_v_cache': _A_in['v_cache'], 'A_wq': _A_in['wq'], 'A_wo': _A_in['wo'], 'B_x': _B_in['x'], 'B_w1': _B_in['w1'], 'B_w3': _B_in['w3'], 'B_w2': _B_in['w2'], 'c': _w((lambda *s: torch.randn(*s, dtype=torch.bfloat16) * 0.2)(1, 512) * 8.0), 'w_mod': _w((lambda *s: torch.randn(*s, dtype=torch.bfloat16) * 0.2)(512, 6 * 512) * 512 ** (-0.5) * 8.0)}

def reference(A_x, A_k_cache, A_v_cache, A_wq, A_wo, B_x, B_w1, B_w3, B_w2, c, w_mod):

    def _A_ref(x, k_cache, v_cache, wq, wo):
        B, Sq, D = x.shape
        H, Dh = (32, 128)
        q = (lambda x, *d: x.permute(*d))((x @ wq).reshape(B, Sq, H, Dh), 0, 2, 1, 3)
        scores = torch.einsum('bhqd,bhkd->bhqk', q, k_cache) * Dh ** (-0.5)
        p = _softmax(scores, axis=-1)
        o = torch.einsum('bhqk,bhkd->bhqd', p, v_cache)
        return (lambda x, *d: x.permute(*d))(o, 0, 2, 1, 3).reshape(B, Sq, H * Dh) @ wo

    def _B_ref(x, w1, w3, w2):
        gate = torch.einsum('bsd,df->bsf', x, w1)
        up = torch.einsum('bsd,df->bsf', x, w3)
        h = _silu(gate) * up
        out = torch.einsum('bsf,fd->bsd', h, w2)
        return out
    x = A_x
    mod = (_silu(c) @ w_mod).reshape(c.shape[0], 6, 1, -1)
    sa, ca, ga, sb, cb, gb = (mod[:, 0].clone(), mod[:, 1].clone(), mod[:, 2].clone(), mod[:, 3].clone(), mod[:, 4].clone(), mod[:, 5].clone())
    h = _layernorm(x, axis=-1) * (1 + ca) + sa
    x = x + ga * _A_ref(h, A_k_cache, A_v_cache, A_wq, A_wo)
    h = _layernorm(x, axis=-1) * (1 + cb) + sb
    x = x + gb * _B_ref(h, B_w1, B_w3, B_w2)
    return x
```

```asm
; @launch grid=(256,1,1) block=(512,1,1) lds=40960
.amdgcn_target "amdgcn-amd-amdhsa--gfx950"
.text
.globl adaLN_cond__mha_block_cached__glu_gated_swiglu__decode_kernel
.p2align 8
.type adaLN_cond__mha_block_cached__glu_gated_swiglu__decode_kernel,@function
adaLN_cond__mha_block_cached__glu_gated_swiglu__decode_kernel:
    s_cmp_ge_u32 s2, 256
    s_cbranch_scc1 L_done
    s_load_dwordx16 s[40:55], s[0:1], 0
    s_load_dwordx8 s[56:63], s[0:1], 64
    s_load_dwordx4 s[64:67], s[0:1], 96
    s_getpc_b64 s[30:31]
L_pc:
    v_lshlrev_b32 v3, 5, v0
    global_load_dword v4, v3, s[30:31]
    v_lshrrev_b32 v2, 6, v0
    v_and_b32 v1, 63, v0
    v_readfirstlane_b32 s3, v2
    s_lshr_b32 s4, s2, 3
    s_and_b32 s5, s2, 7
    s_mov_b32 s26, 0x3fb8aa3b
    s_mov_b32 s28, 0xffff0000
    s_mov_b64 s[34:35], exec
    s_mov_b32 s24, 0x05040100
    s_mov_b32 s25, 0x07060302
    s_sub_u32 s7, s3, 4
    s_waitcnt lgkmcnt(0)
    s_load_dword s22, s[66:67], 0
    s_cmp_lt_u32 s3, 4
    s_cbranch_scc1 L_stream
    s_cmp_lg_u32 s3, 4
    s_cbranch_scc1 L_service
    v_lshrrev_b32 v10, 2, v1
    s_lshl_b32 s29, s5, 4
    v_add_u32 v10, s29, v10
    v_lshlrev_b32 v3, 3, v10
    global_load_dwordx2 v[8:9], v3, s[58:59]
    v_mul_u32_u24 v10, 24576, v10
    v_bfe_u32 v5, v1, 1, 1
    v_lshl_add_u32 v10, v5, 10, v10
    v_and_b32 v5, 1, v1
    v_lshl_add_u32 v10, v5, 4, v10
    s_lshl_b32 s29, s4, 5
    v_add_u32 v10, s29, v10
    global_load_dwordx4 v[32:35], v10, s[60:61] nt
    v_add_u32 v10, 6144, v10
    global_load_dwordx4 v[36:39], v10, s[60:61] nt
    v_add_u32 v10, 6144, v10
    global_load_dwordx4 v[40:43], v10, s[60:61] nt
    v_add_u32 v10, 6144, v10
    global_load_dwordx4 v[44:47], v10, s[60:61] nt
    v_lshlrev_b32 v3, 4, v1
    global_load_dwordx4 v[12:15], v3, s[40:41]
    s_lshl_b32 s29, s5, 7
    v_lshl_add_u32 v3, v1, 1, s29
    global_load_ushort v6, v3, s[40:41]
    v_lshrrev_b32 v10, 4, v1
    v_lshlrev_b32 v10, 17, v10
    v_and_b32 v5, 15, v1
    v_lshl_add_u32 v10, v5, 4, v10
    s_lshl_b32 s29, s5, 19
    s_lshl_b32 s30, s4, 8
    s_add_u32 s29, s29, s30
    v_add_u32 v10, s29, v10
    global_load_dwordx4 v[64:67], v10, s[46:47] nt
    v_add_u32 v10, 8192, v10
    global_load_dwordx4 v[68:71], v10, s[46:47] nt
    v_add_u32 v10, 8192, v10
    global_load_dwordx4 v[72:75], v10, s[46:47] nt
    v_add_u32 v10, 8192, v10
    global_load_dwordx4 v[76:79], v10, s[46:47] nt
    v_add_u32 v10, 8192, v10
    global_load_dwordx4 v[80:83], v10, s[46:47] nt
    v_add_u32 v10, 8192, v10
    global_load_dwordx4 v[84:87], v10, s[46:47] nt
    v_add_u32 v10, 8192, v10
    global_load_dwordx4 v[88:91], v10, s[46:47] nt
    v_add_u32 v10, 8192, v10
    global_load_dwordx4 v[92:95], v10, s[46:47] nt
    v_add_u32 v10, 8192, v10
    global_load_dwordx4 v[96:99], v10, s[46:47] nt
    v_add_u32 v10, 8192, v10
    global_load_dwordx4 v[100:103], v10, s[46:47] nt
    v_add_u32 v10, 8192, v10
    global_load_dwordx4 v[104:107], v10, s[46:47] nt
    v_add_u32 v10, 8192, v10
    global_load_dwordx4 v[108:111], v10, s[46:47] nt
    v_add_u32 v10, 8192, v10
    global_load_dwordx4 v[112:115], v10, s[46:47] nt
    v_add_u32 v10, 8192, v10
    global_load_dwordx4 v[116:119], v10, s[46:47] nt
    v_add_u32 v10, 8192, v10
    global_load_dwordx4 v[120:123], v10, s[46:47] nt
    v_add_u32 v10, 8192, v10
    global_load_dwordx4 v[124:127], v10, s[46:47] nt
    s_xor_b32 s30, s4, s5
    s_and_b32 s30, s30, 3
    s_lshr_b32 s37, s4, 2
    s_mov_b32 s6, 3
    s_cmp_eq_u32 s30, 0
    s_cselect_b32 s6, 0, s6
    s_lshr_b32 s29, s5, 2
    s_add_u32 s29, s29, s30
    s_lshl_b32 s29, s29, 2
    s_add_u32 s29, s29, s30
    s_cmp_eq_u32 s29, 15
    s_cselect_b32 s6, 2, s6
    s_cselect_b32 s37, s4, s37
    s_cmp_eq_u32 s5, 7
    s_cselect_b32 s30, 2, s30
    s_lshl_b32 s29, s5, 3
    s_add_u32 s29, s29, s37
    s_cmp_eq_u32 s30, 1
    s_cselect_b32 s6, 1, s6
    s_cselect_b32 s37, s29, s37
    v_mov_b32 v56, -1
    v_mov_b32 v57, -1
    v_mov_b32 v58, -1
    v_mov_b32 v59, -1
    s_lshl_b32 s29, s2, 10
    s_add_u32 s29, s29, 65536
    v_lshl_add_u32 v238, v1, 3, s29
    v_min_u32 v5, 39, v1
    v_lshl_add_u32 v60, v5, 4, s29
    v_mov_b32 v62, v60
    v_mov_b32 v63, v60
    s_cmp_eq_u32 s6, 1
    s_cbranch_scc0 L_cl1
    s_lshl_b32 s29, s37, 11
    s_add_u32 s29, s29, 524288
    v_lshl_add_u32 v62, v1, 4, s29
    v_add_u32 v63, 1024, v62
L_cl1:
    s_cmp_eq_u32 s6, 0
    s_cbranch_scc0 L_cl2
    s_lshl_b32 s29, s5, 11
    s_lshl_b32 s30, s37, 8
    s_add_u32 s29, s29, s30
    s_add_u32 s29, s29, 393216
    v_and_b32 v63, 15, v1
    v_lshl_add_u32 v63, v63, 4, s29
    v_lshrrev_b32 v5, 4, v1
    v_lshl_add_u32 v63, v5, 14, v63
L_cl2:
    global_store_dwordx4 v60, v[56:59], s[66:67] sc1
    s_cmp_lt_u32 s6, 2
    s_cselect_b64 exec, -1, 1
    global_store_dwordx4 v63, v[56:59], s[66:67] sc1
    s_cmp_eq_u32 s6, 1
    s_cselect_b64 exec, -1, 1
    global_store_dwordx4 v62, v[56:59], s[66:67] sc1
    s_mul_i32 s29, s4, 256
    s_lshl_b32 s30, s5, 5
    s_add_u32 s29, s29, s30
    s_add_u32 s29, s29, 32768
    s_mov_b64 exec, 1
    v_mov_b32 v61, s29
    v_mov_b32 v5, 0
    global_store_dword v61, v5, s[66:67] sc1
    s_mov_b64 exec, s[34:35]
    s_nop 1
    v_bfe_u32 v7, v1, 2, 1
    v_bfe_u32 v5, v1, 3, 1
    v_lshl_add_u32 v7, v5, 2, v7
    v_bfe_u32 v5, v1, 4, 1
    v_lshl_add_u32 v7, v5, 1, v7
    v_and_b32 v5, 1, v1
    v_lshl_add_u32 v7, v5, 3, v7
    v_lshlrev_b32 v7, 4, v7
    v_bfe_u32 v5, v1, 1, 1
    v_lshl_add_u32 v7, v5, 3, v7
    s_lshl_b32 s29, s5, 5
    s_add_u32 s29, s29, s4
    s_lshl_b32 s29, s29, 8
    s_add_u32 s29, s29, 786432
    v_add_u32 v7, s29, v7
    v_mov_b32 v48, 0
    v_mov_b32 v49, 0
    v_mov_b32 v50, 0
    v_mov_b32 v51, 0
    v_mov_b32 v52, 0
    v_mov_b32 v53, 0
    v_mov_b32 v54, 0
    v_mov_b32 v55, 0
    s_waitcnt vmcnt(26)
    v_and_b32 v17, 0xffff0000, v8
    v_lshlrev_b32 v16, 16, v8
    v_and_b32 v19, 0xffff0000, v9
    v_lshlrev_b32 v18, 16, v9
    v_mul_f32 v20, 0xbfb8aa3b, v16
    v_mul_f32 v21, 0xbfb8aa3b, v17
    v_mul_f32 v22, 0xbfb8aa3b, v18
    v_mul_f32 v23, 0xbfb8aa3b, v19
    v_exp_f32 v20, v20
    v_exp_f32 v21, v21
    v_exp_f32 v22, v22
    v_exp_f32 v23, v23
    v_add_f32 v20, 1.0, v20
    v_add_f32 v21, 1.0, v21
    v_add_f32 v22, 1.0, v22
    v_add_f32 v23, 1.0, v23
    v_rcp_f32 v20, v20
    v_rcp_f32 v21, v21
    v_rcp_f32 v22, v22
    v_rcp_f32 v23, v23
    v_mul_f32 v16, v16, v20
    v_mul_f32 v17, v17, v21
    v_mul_f32 v18, v18, v22
    v_mul_f32 v19, v19, v23
    v_cvt_pk_bf16_f32 v20, v16, 0
    v_cvt_pk_bf16_f32 v24, 0, v16
    v_cvt_pk_bf16_f32 v21, v17, 0
    v_cvt_pk_bf16_f32 v25, 0, v17
    v_cvt_pk_bf16_f32 v22, v18, 0
    v_cvt_pk_bf16_f32 v26, 0, v18
    v_cvt_pk_bf16_f32 v23, v19, 0
    v_cvt_pk_bf16_f32 v27, 0, v19
    s_waitcnt lgkmcnt(0)
    s_mul_i32 s22, s22, 0x9e3779b1
    s_add_u32 s22, s22, 0x7f4a7c15
    s_waitcnt vmcnt(25)
    v_dot2c_f32_bf16 v48, v20, v32
    v_dot2c_f32_bf16 v49, v24, v32
    v_dot2c_f32_bf16 v50, v20, v33
    v_dot2c_f32_bf16 v51, v24, v33
    v_dot2c_f32_bf16 v52, v20, v34
    v_dot2c_f32_bf16 v53, v24, v34
    v_dot2c_f32_bf16 v54, v20, v35
    v_dot2c_f32_bf16 v55, v24, v35
    s_waitcnt vmcnt(24)
    v_dot2c_f32_bf16 v48, v21, v36
    v_dot2c_f32_bf16 v49, v25, v36
    v_dot2c_f32_bf16 v50, v21, v37
    v_dot2c_f32_bf16 v51, v25, v37
    v_dot2c_f32_bf16 v52, v21, v38
    v_dot2c_f32_bf16 v53, v25, v38
    v_dot2c_f32_bf16 v54, v21, v39
    v_dot2c_f32_bf16 v55, v25, v39
    s_waitcnt vmcnt(23)
    v_dot2c_f32_bf16 v48, v22, v40
    v_dot2c_f32_bf16 v49, v26, v40
    v_dot2c_f32_bf16 v50, v22, v41
    v_dot2c_f32_bf16 v51, v26, v41
    v_dot2c_f32_bf16 v52, v22, v42
    v_dot2c_f32_bf16 v53, v26, v42
    v_dot2c_f32_bf16 v54, v22, v43
    v_dot2c_f32_bf16 v55, v26, v43
    s_waitcnt vmcnt(22)
    v_dot2c_f32_bf16 v48, v23, v44
    v_dot2c_f32_bf16 v49, v27, v44
    v_dot2c_f32_bf16 v50, v23, v45
    v_dot2c_f32_bf16 v51, v27, v45
    v_dot2c_f32_bf16 v52, v23, v46
    v_dot2c_f32_bf16 v53, v27, v46
    v_dot2c_f32_bf16 v54, v23, v47
    v_dot2c_f32_bf16 v55, v27, v47
    v_add_f32_dpp v48, v48, v48 row_ror:8 row_mask:0xf bank_mask:0x3
    v_add_f32_dpp v49, v49, v49 row_ror:8 row_mask:0xf bank_mask:0x3
    v_add_f32_dpp v50, v50, v50 row_ror:8 row_mask:0xf bank_mask:0x3
    v_add_f32_dpp v51, v51, v51 row_ror:8 row_mask:0xf bank_mask:0x3
    v_add_f32_dpp v48, v52, v52 row_ror:8 row_mask:0xf bank_mask:0xc
    v_add_f32_dpp v49, v53, v53 row_ror:8 row_mask:0xf bank_mask:0xc
    v_add_f32_dpp v50, v54, v54 row_ror:8 row_mask:0xf bank_mask:0xc
    v_add_f32_dpp v51, v55, v55 row_ror:8 row_mask:0xf bank_mask:0xc
    v_add_f32_dpp v48, v48, v48 row_shl:4 row_mask:0xf bank_mask:0x5
    v_add_f32_dpp v50, v50, v50 row_shl:4 row_mask:0xf bank_mask:0x5
    s_nop 0
    v_add_f32_dpp v48, v49, v49 row_shr:4 row_mask:0xf bank_mask:0xa
    v_add_f32_dpp v50, v51, v51 row_shr:4 row_mask:0xf bank_mask:0xa
    s_nop 1
    v_permlane16_swap_b32 v48, v50
    v_add_f32 v48, v48, v50
    v_mov_b32 v49, v48
    s_nop 1
    v_permlane32_swap_b32 v48, v49
    v_add_f32 v48, v48, v49
    v_mov_b32 v49, s22
    s_mov_b32 exec_hi, 0
    global_store_dwordx2 v7, v[48:49], s[66:67] sc1
    s_mov_b64 exec, s[34:35]
    s_waitcnt vmcnt(21)
    v_and_b32 v17, 0xffff0000, v12
    v_lshlrev_b32 v16, 16, v12
    v_and_b32 v19, 0xffff0000, v13
    v_lshlrev_b32 v18, 16, v13
    v_and_b32 v21, 0xffff0000, v14
    v_lshlrev_b32 v20, 16, v14
    v_and_b32 v23, 0xffff0000, v15
    v_lshlrev_b32 v22, 16, v15
    v_add_f32 v24, v16, v17
    v_add_f32 v24, v24, v18
    v_add_f32 v24, v24, v19
    v_add_f32 v24, v24, v20
    v_add_f32 v24, v24, v21
    v_add_f32 v24, v24, v22
    v_add_f32 v24, v24, v23
    s_nop 1
    v_add_f32_dpp v24, v24, v24 row_ror:8 row_mask:0xf bank_mask:0xf
    s_nop 1
    v_add_f32_dpp v24, v24, v24 row_ror:4 row_mask:0xf bank_mask:0xf
    s_nop 1
    v_add_f32_dpp v24, v24, v24 row_ror:2 row_mask:0xf bank_mask:0xf
    s_nop 1
    v_add_f32_dpp v24, v24, v24 row_ror:1 row_mask:0xf bank_mask:0xf
    v_mov_b32 v26, v24
    s_nop 1
    v_permlane16_swap_b32 v24, v26
    v_add_f32 v24, v24, v26
    v_mov_b32 v26, v24
    s_nop 1
    v_permlane32_swap_b32 v24, v26
    v_add_f32 v24, v24, v26
    v_mul_f32 v24, 0x3b000000, v24
    v_sub_f32 v16, v16, v24
    v_sub_f32 v17, v17, v24
    v_sub_f32 v18, v18, v24
    v_sub_f32 v19, v19, v24
    v_sub_f32 v20, v20, v24
    v_sub_f32 v21, v21, v24
    v_sub_f32 v22, v22, v24
    v_sub_f32 v23, v23, v24
    v_mul_f32 v25, v16, v16
    v_fmac_f32 v25, v17, v17
    v_fmac_f32 v25, v18, v18
    v_fmac_f32 v25, v19, v19
    v_fmac_f32 v25, v20, v20
    v_fmac_f32 v25, v21, v21
    v_fmac_f32 v25, v22, v22
    v_fmac_f32 v25, v23, v23
    s_nop 1
    v_add_f32_dpp v25, v25, v25 row_ror:8 row_mask:0xf bank_mask:0xf
    s_nop 1
    v_add_f32_dpp v25, v25, v25 row_ror:4 row_mask:0xf bank_mask:0xf
    s_nop 1
    v_add_f32_dpp v25, v25, v25 row_ror:2 row_mask:0xf bank_mask:0xf
    s_nop 1
    v_add_f32_dpp v25, v25, v25 row_ror:1 row_mask:0xf bank_mask:0xf
    v_mov_b32 v26, v25
    s_nop 1
    v_permlane16_swap_b32 v25, v26
    v_add_f32 v25, v25, v26
    v_mov_b32 v26, v25
    s_nop 1
    v_permlane32_swap_b32 v25, v26
    v_add_f32 v25, v25, v26
    v_mul_f32 v25, 0x3b000000, v25
    v_cvt_pk_bf16_f32 v25, 0, v25
    v_cvt_pk_bf16_f32 v24, 0, v24
    v_add_f32 v25, 0x3727c5ac, v25
    v_cvt_pk_bf16_f32 v25, 0, v25
    v_sqrt_f32 v25, v25
    s_nop 0
    v_cvt_pk_bf16_f32 v25, 0, v25
    v_lshlrev_b32 v6, 16, v6
    v_rcp_f32 v26, v25
    v_sub_f32 v6, v6, v24
    v_cvt_pk_bf16_f32 v6, 0, v6
    v_mul_f32 v27, v6, v26
    v_fma_f32 v6, -v27, v25, v6
    v_fma_f32 v6, v6, v26, v27
    v_cvt_pk_bf16_f32 v6, 0, v6
    s_lshl_b32 s29, s5, 10
    s_add_u32 s29, s29, 786432
    v_lshl_add_u32 v8, v1, 4, s29
    v_add_u32 v9, 8192, v8
    v_add_u32 v10, 16384, v8
    v_add_u32 v11, 24576, v8
    v_add_u32 v12, 32768, v8
    v_add_u32 v13, 40960, v8
    v_add_u32 v14, 49152, v8
    v_add_u32 v15, 57344, v8
    s_waitcnt vmcnt(19)
    v_perm_b32 v20, v68, v64, s24
    v_perm_b32 v68, v68, v64, s25
    v_mov_b32 v64, v20
    v_perm_b32 v20, v69, v65, s24
    v_perm_b32 v69, v69, v65, s25
    v_mov_b32 v65, v20
    v_perm_b32 v20, v70, v66, s24
    v_perm_b32 v70, v70, v66, s25
    v_mov_b32 v66, v20
    v_perm_b32 v20, v71, v67, s24
    v_perm_b32 v71, v71, v67, s25
    v_mov_b32 v67, v20
    s_waitcnt vmcnt(17)
    v_perm_b32 v20, v76, v72, s24
    v_perm_b32 v76, v76, v72, s25
    v_mov_b32 v72, v20
    v_perm_b32 v20, v77, v73, s24
    v_perm_b32 v77, v77, v73, s25
    v_mov_b32 v73, v20
    v_perm_b32 v20, v78, v74, s24
    v_perm_b32 v78, v78, v74, s25
    v_mov_b32 v74, v20
    v_perm_b32 v20, v79, v75, s24
    v_perm_b32 v79, v79, v75, s25
    v_mov_b32 v75, v20
    s_waitcnt vmcnt(15)
    v_perm_b32 v20, v84, v80, s24
    v_perm_b32 v84, v84, v80, s25
    v_mov_b32 v80, v20
    v_perm_b32 v20, v85, v81, s24
    v_perm_b32 v85, v85, v81, s25
    v_mov_b32 v81, v20
    v_perm_b32 v20, v86, v82, s24
    v_perm_b32 v86, v86, v82, s25
    v_mov_b32 v82, v20
    v_perm_b32 v20, v87, v83, s24
    v_perm_b32 v87, v87, v83, s25
    v_mov_b32 v83, v20
    s_waitcnt vmcnt(13)
    v_perm_b32 v20, v92, v88, s24
    v_perm_b32 v92, v92, v88, s25
    v_mov_b32 v88, v20
    v_perm_b32 v20, v93, v89, s24
    v_perm_b32 v93, v93, v89, s25
    v_mov_b32 v89, v20
    v_perm_b32 v20, v94, v90, s24
    v_perm_b32 v94, v94, v90, s25
    v_mov_b32 v90, v20
    v_perm_b32 v20, v95, v91, s24
    v_perm_b32 v95, v95, v91, s25
    v_mov_b32 v91, v20
    s_waitcnt vmcnt(11)
    v_perm_b32 v20, v100, v96, s24
    v_perm_b32 v100, v100, v96, s25
    v_mov_b32 v96, v20
    v_perm_b32 v20, v101, v97, s24
    v_perm_b32 v101, v101, v97, s25
    v_mov_b32 v97, v20
    v_perm_b32 v20, v102, v98, s24
    v_perm_b32 v102, v102, v98, s25
    v_mov_b32 v98, v20
    v_perm_b32 v20, v103, v99, s24
    v_perm_b32 v103, v103, v99, s25
    v_mov_b32 v99, v20
    s_waitcnt vmcnt(9)
    v_perm_b32 v20, v108, v104, s24
    v_perm_b32 v108, v108, v104, s25
    v_mov_b32 v104, v20
    v_perm_b32 v20, v109, v105, s24
    v_perm_b32 v109, v109, v105, s25
    v_mov_b32 v105, v20
    v_perm_b32 v20, v110, v106, s24
    v_perm_b32 v110, v110, v106, s25
    v_mov_b32 v106, v20
    v_perm_b32 v20, v111, v107, s24
    v_perm_b32 v111, v111, v107, s25
    v_mov_b32 v107, v20
    s_waitcnt vmcnt(7)
    v_perm_b32 v20, v116, v112, s24
    v_perm_b32 v116, v116, v112, s25
    v_mov_b32 v112, v20
    v_perm_b32 v20, v117, v113, s24
    v_perm_b32 v117, v117, v113, s25
    v_mov_b32 v113, v20
    v_perm_b32 v20, v118, v114, s24
    v_perm_b32 v118, v118, v114, s25
    v_mov_b32 v114, v20
    v_perm_b32 v20, v119, v115, s24
    v_perm_b32 v119, v119, v115, s25
    v_mov_b32 v115, v20
    s_waitcnt vmcnt(5)
    v_perm_b32 v20, v124, v120, s24
    v_perm_b32 v124, v124, v120, s25
    v_mov_b32 v120, v20
    v_perm_b32 v20, v125, v121, s24
    v_perm_b32 v125, v125, v121, s25
    v_mov_b32 v121, v20
    v_perm_b32 v20, v126, v122, s24
    v_perm_b32 v126, v126, v122, s25
    v_mov_b32 v122, v20
    v_perm_b32 v20, v127, v123, s24
    v_perm_b32 v127, v127, v123, s25
    v_mov_b32 v123, v20
    v_mov_b32 v48, 0
    v_mov_b32 v49, 0
    v_mov_b32 v50, 0
    v_mov_b32 v51, 0
    v_mov_b32 v52, 0
    v_mov_b32 v53, 0
    v_mov_b32 v54, 0
    v_mov_b32 v55, 0
    v_and_b32 v7, 15, v1
    v_lshlrev_b32 v7, 6, v7
    v_lshrrev_b32 v5, 4, v1
    v_lshl_add_u32 v7, v5, 4, v7
    s_lshl_b32 s29, s2, 10
    s_add_u32 s29, s29, 1048576
    v_add_u32 v7, s29, v7
    s_mov_b32 s36, 0x40000
    s_nop 1
L_poll_1:
    global_load_dwordx4 v[128:131], v8, s[66:67] sc1
    global_load_dwordx4 v[132:135], v9, s[66:67] sc1
    global_load_dwordx4 v[136:139], v10, s[66:67] sc1
    global_load_dwordx4 v[140:143], v11, s[66:67] sc1
    global_load_dwordx4 v[144:147], v12, s[66:67] sc1
    global_load_dwordx4 v[148:151], v13, s[66:67] sc1
    global_load_dwordx4 v[152:155], v14, s[66:67] sc1
    global_load_dwordx4 v[156:159], v15, s[66:67] sc1
    s_waitcnt vmcnt(0)
    v_min3_u32 v28, v129, v131, v133
    v_max3_u32 v29, v129, v131, v133
    v_min3_u32 v28, v28, v135, v137
    v_max3_u32 v29, v29, v135, v137
    v_min3_u32 v28, v28, v139, v141
    v_max3_u32 v29, v29, v139, v141
    v_min3_u32 v28, v28, v143, v145
    v_max3_u32 v29, v29, v143, v145
    v_min3_u32 v28, v28, v147, v149
    v_max3_u32 v29, v29, v147, v149
    v_min3_u32 v28, v28, v151, v153
    v_max3_u32 v29, v29, v151, v153
    v_min3_u32 v28, v28, v155, v157
    v_max3_u32 v29, v29, v155, v157
    v_min_u32 v28, v28, v159
    v_max_u32 v29, v29, v159
    v_xor_b32 v28, s22, v28
    v_xor_b32 v29, s22, v29
    v_or_b32 v28, v28, v29
    v_cmp_ne_u32 vcc, 0, v28
    s_cbranch_vccz L_pdone_2
    s_sleep 2
    s_sub_u32 s36, s36, 1
    s_cbranch_scc0 L_poll_1
L_pdone_2:
    v_add_f32 v128, v128, v144
    v_add_f32 v130, v130, v146
    v_add_f32 v132, v132, v148
    v_add_f32 v134, v134, v150
    v_add_f32 v136, v136, v152
    v_add_f32 v138, v138, v154
    v_add_f32 v140, v140, v156
    v_add_f32 v142, v142, v158
    v_add_f32 v128, v128, v136
    v_add_f32 v130, v130, v138
    v_add_f32 v132, v132, v140
    v_add_f32 v134, v134, v142
    v_add_f32 v128, v128, v132
    v_add_f32 v130, v130, v134
    v_cvt_pk_bf16_f32 v128, 0, v128
    v_cvt_pk_bf16_f32 v130, 0, v130
    v_add_f32 v130, 1.0, v130
    v_cvt_pk_bf16_f32 v130, 0, v130
    v_mul_f32 v6, v6, v130
    v_cvt_pk_bf16_f32 v6, 0, v6
    v_add_f32 v6, v6, v128
    s_nop 1
    v_mov_b32_dpp v5, v6 quad_perm:[1,1,3,3] row_mask:0xf bank_mask:0xf
    v_cvt_pk_bf16_f32 v23, v6, v5
    s_nop 1
    v_dot2c_f32_bf16_dpp v48, v23, v64 row_newbcast:0 row_mask:0xf bank_mask:0xf
    v_dot2c_f32_bf16_dpp v49, v23, v68 row_newbcast:0 row_mask:0xf bank_mask:0xf
    v_dot2c_f32_bf16_dpp v50, v23, v65 row_newbcast:0 row_mask:0xf bank_mask:0xf
    v_dot2c_f32_bf16_dpp v51, v23, v69 row_newbcast:0 row_mask:0xf bank_mask:0xf
    v_dot2c_f32_bf16_dpp v52, v23, v66 row_newbcast:0 row_mask:0xf bank_mask:0xf
    v_dot2c_f32_bf16_dpp v53, v23, v70 row_newbcast:0 row_mask:0xf bank_mask:0xf
    v_dot2c_f32_bf16_dpp v54, v23, v67 row_newbcast:0 row_mask:0xf bank_mask:0xf
    v_dot2c_f32_bf16_dpp v55, v23, v71 row_newbcast:0 row_mask:0xf bank_mask:0xf
    v_dot2c_f32_bf16_dpp v48, v23, v72 row_newbcast:2 row_mask:0xf bank_mask:0xf
    v_dot2c_f32_bf16_dpp v49, v23, v76 row_newbcast:2 row_mask:0xf bank_mask:0xf
    v_dot2c_f32_bf16_dpp v50, v23, v73 row_newbcast:2 row_mask:0xf bank_mask:0xf
    v_dot2c_f32_bf16_dpp v51, v23, v77 row_newbcast:2 row_mask:0xf bank_mask:0xf
    v_dot2c_f32_bf16_dpp v52, v23, v74 row_newbcast:2 row_mask:0xf bank_mask:0xf
    v_dot2c_f32_bf16_dpp v53, v23, v78 row_newbcast:2 row_mask:0xf bank_mask:0xf
    v_dot2c_f32_bf16_dpp v54, v23, v75 row_newbcast:2 row_mask:0xf bank_mask:0xf
    v_dot2c_f32_bf16_dpp v55, v23, v79 row_newbcast:2 row_mask:0xf bank_mask:0xf
    v_dot2c_f32_bf16_dpp v48, v23, v80 row_newbcast:4 row_mask:0xf bank_mask:0xf
    v_dot2c_f32_bf16_dpp v49, v23, v84 row_newbcast:4 row_mask:0xf bank_mask:0xf
    v_dot2c_f32_bf16_dpp v50, v23, v81 row_newbcast:4 row_mask:0xf bank_mask:0xf
    v_dot2c_f32_bf16_dpp v51, v23, v85 row_newbcast:4 row_mask:0xf bank_mask:0xf
    v_dot2c_f32_bf16_dpp v52, v23, v82 row_newbcast:4 row_mask:0xf bank_mask:0xf
    v_dot2c_f32_bf16_dpp v53, v23, v86 row_newbcast:4 row_mask:0xf bank_mask:0xf
    v_dot2c_f32_bf16_dpp v54, v23, v83 row_newbcast:4 row_mask:0xf bank_mask:0xf
    v_dot2c_f32_bf16_dpp v55, v23, v87 row_newbcast:4 row_mask:0xf bank_mask:0xf
    v_dot2c_f32_bf16_dpp v48, v23, v88 row_newbcast:6 row_mask:0xf bank_mask:0xf
    v_dot2c_f32_bf16_dpp v49, v23, v92 row_newbcast:6 row_mask:0xf bank_mask:0xf
    v_dot2c_f32_bf16_dpp v50, v23, v89 row_newbcast:6 row_mask:0xf bank_mask:0xf
    v_dot2c_f32_bf16_dpp v51, v23, v93 row_newbcast:6 row_mask:0xf bank_mask:0xf
    v_dot2c_f32_bf16_dpp v52, v23, v90 row_newbcast:6 row_mask:0xf bank_mask:0xf
    v_dot2c_f32_bf16_dpp v53, v23, v94 row_newbcast:6 row_mask:0xf bank_mask:0xf
    v_dot2c_f32_bf16_dpp v54, v23, v91 row_newbcast:6 row_mask:0xf bank_mask:0xf
    v_dot2c_f32_bf16_dpp v55, v23, v95 row_newbcast:6 row_mask:0xf bank_mask:0xf
    v_dot2c_f32_bf16_dpp v48, v23, v96 row_newbcast:8 row_mask:0xf bank_mask:0xf
    v_dot2c_f32_bf16_dpp v49, v23, v100 row_newbcast:8 row_mask:0xf bank_mask:0xf
    v_dot2c_f32_bf16_dpp v50, v23, v97 row_newbcast:8 row_mask:0xf bank_mask:0xf
    v_dot2c_f32_bf16_dpp v51, v23, v101 row_newbcast:8 row_mask:0xf bank_mask:0xf
    v_dot2c_f32_bf16_dpp v52, v23, v98 row_newbcast:8 row_mask:0xf bank_mask:0xf
    v_dot2c_f32_bf16_dpp v53, v23, v102 row_newbcast:8 row_mask:0xf bank_mask:0xf
    v_dot2c_f32_bf16_dpp v54, v23, v99 row_newbcast:8 row_mask:0xf bank_mask:0xf
    v_dot2c_f32_bf16_dpp v55, v23, v103 row_newbcast:8 row_mask:0xf bank_mask:0xf
    v_dot2c_f32_bf16_dpp v48, v23, v104 row_newbcast:10 row_mask:0xf bank_mask:0xf
    v_dot2c_f32_bf16_dpp v49, v23, v108 row_newbcast:10 row_mask:0xf bank_mask:0xf
    v_dot2c_f32_bf16_dpp v50, v23, v105 row_newbcast:10 row_mask:0xf bank_mask:0xf
    v_dot2c_f32_bf16_dpp v51, v23, v109 row_newbcast:10 row_mask:0xf bank_mask:0xf
    v_dot2c_f32_bf16_dpp v52, v23, v106 row_newbcast:10 row_mask:0xf bank_mask:0xf
    v_dot2c_f32_bf16_dpp v53, v23, v110 row_newbcast:10 row_mask:0xf bank_mask:0xf
    v_dot2c_f32_bf16_dpp v54, v23, v107 row_newbcast:10 row_mask:0xf bank_mask:0xf
    v_dot2c_f32_bf16_dpp v55, v23, v111 row_newbcast:10 row_mask:0xf bank_mask:0xf
    v_dot2c_f32_bf16_dpp v48, v23, v112 row_newbcast:12 row_mask:0xf bank_mask:0xf
    v_dot2c_f32_bf16_dpp v49, v23, v116 row_newbcast:12 row_mask:0xf bank_mask:0xf
    v_dot2c_f32_bf16_dpp v50, v23, v113 row_newbcast:12 row_mask:0xf bank_mask:0xf
    v_dot2c_f32_bf16_dpp v51, v23, v117 row_newbcast:12 row_mask:0xf bank_mask:0xf
    v_dot2c_f32_bf16_dpp v52, v23, v114 row_newbcast:12 row_mask:0xf bank_mask:0xf
    v_dot2c_f32_bf16_dpp v53, v23, v118 row_newbcast:12 row_mask:0xf bank_mask:0xf
    v_dot2c_f32_bf16_dpp v54, v23, v115 row_newbcast:12 row_mask:0xf bank_mask:0xf
    v_dot2c_f32_bf16_dpp v55, v23, v119 row_newbcast:12 row_mask:0xf bank_mask:0xf
    v_dot2c_f32_bf16_dpp v48, v23, v120 row_newbcast:14 row_mask:0xf bank_mask:0xf
    v_dot2c_f32_bf16_dpp v49, v23, v124 row_newbcast:14 row_mask:0xf bank_mask:0xf
    v_dot2c_f32_bf16_dpp v50, v23, v121 row_newbcast:14 row_mask:0xf bank_mask:0xf
    v_dot2c_f32_bf16_dpp v51, v23, v125 row_newbcast:14 row_mask:0xf bank_mask:0xf
    v_dot2c_f32_bf16_dpp v52, v23, v122 row_newbcast:14 row_mask:0xf bank_mask:0xf
    v_dot2c_f32_bf16_dpp v53, v23, v126 row_newbcast:14 row_mask:0xf bank_mask:0xf
    v_dot2c_f32_bf16_dpp v54, v23, v123 row_newbcast:14 row_mask:0xf bank_mask:0xf
    v_dot2c_f32_bf16_dpp v55, v23, v127 row_newbcast:14 row_mask:0xf bank_mask:0xf
    v_permlane32_swap_b32 v48, v52
    v_permlane32_swap_b32 v49, v53
    v_permlane32_swap_b32 v50, v54
    v_permlane32_swap_b32 v51, v55
    v_add_f32 v48, v48, v52
    v_add_f32 v49, v49, v53
    v_add_f32 v50, v50, v54
    v_add_f32 v51, v51, v55
    s_nop 0
    v_permlane16_swap_b32 v48, v50
    v_permlane16_swap_b32 v49, v51
    v_add_f32 v48, v48, v50
    v_add_f32 v49, v49, v51
    v_mov_b32 v50, v49
    v_mov_b32 v49, s22
    v_mov_b32 v51, s22
    global_store_dwordx4 v7, v[48:51], s[66:67] sc1
    s_lshl_b32 s29, s4, 13
    s_add_u32 s29, s29, 1048576
    v_lshl_add_u32 v8, v1, 4, s29
    v_add_u32 v9, 4096, v8
    v_lshlrev_b32 v3, 2, v1
    s_mov_b32 s36, 0x40000
    s_nop 1
L_poll_3:
    global_load_dwordx4 v[128:131], v8, s[66:67] offset:0 sc1
    global_load_dwordx4 v[132:135], v8, s[66:67] offset:1024 sc1
    global_load_dwordx4 v[136:139], v8, s[66:67] offset:2048 sc1
    global_load_dwordx4 v[140:143], v8, s[66:67] offset:3072 sc1
    global_load_dwordx4 v[144:147], v9, s[66:67] offset:0 sc1
    global_load_dwordx4 v[148:151], v9, s[66:67] offset:1024 sc1
    global_load_dwordx4 v[152:155], v9, s[66:67] offset:2048 sc1
    global_load_dwordx4 v[156:159], v9, s[66:67] offset:3072 sc1
    s_waitcnt vmcnt(0)
    v_min3_u32 v28, v129, v131, v133
    v_max3_u32 v29, v129, v131, v133
    v_min3_u32 v28, v28, v135, v137
    v_max3_u32 v29, v29, v135, v137
    v_min3_u32 v28, v28, v139, v141
    v_max3_u32 v29, v29, v139, v141
    v_min3_u32 v28, v28, v143, v145
    v_max3_u32 v29, v29, v143, v145
    v_min3_u32 v28, v28, v147, v149
    v_max3_u32 v29, v29, v147, v149
    v_min3_u32 v28, v28, v151, v153
    v_max3_u32 v29, v29, v151, v153
    v_min3_u32 v28, v28, v155, v157
    v_max3_u32 v29, v29, v155, v157
    v_min_u32 v28, v28, v159
    v_max_u32 v29, v29, v159
    v_xor_b32 v28, s22, v28
    v_xor_b32 v29, s22, v29
    v_or_b32 v28, v28, v29
    v_cmp_ne_u32 vcc, 0, v28
    s_cbranch_vccz L_pdone_4
    s_sleep 2
    s_sub_u32 s36, s36, 1
    s_cbranch_scc0 L_poll_3
L_pdone_4:
    v_add_f32 v128, v128, v144
    v_add_f32 v130, v130, v146
    v_add_f32 v132, v132, v148
    v_add_f32 v134, v134, v150
    v_add_f32 v136, v136, v152
    v_add_f32 v138, v138, v154
    v_add_f32 v140, v140, v156
    v_add_f32 v142, v142, v158
    v_add_f32 v128, v128, v136
    v_add_f32 v130, v130, v138
    v_add_f32 v132, v132, v140
    v_add_f32 v134, v134, v142
    v_add_f32 v128, v128, v132
    v_add_f32 v130, v130, v134
    v_cvt_pk_bf16_f32 v5, v128, v130
    ds_write_b32 v3, v5 offset:8448
    s_waitcnt lgkmcnt(0)
    s_barrier
    v_lshlrev_b32 v236, 3, v1
    v_and_b32 v237, 15, v1
    v_lshlrev_b32 v237, 3, v237
    s_branch L_roles
L_stream:
    s_lshl_b32 s19, s4, 24
    s_add_u32 s8, s42, s19
    s_addc_u32 s9, s43, 0
    s_mov_b32 s10, 0x1000000
    s_mov_b32 s11, 0x20000
    v_lshlrev_b32 v19, 4, v1
    s_lshl_b32 s29, s3, 12
    s_lshl_b32 s20, s5, 21
    s_add_u32 s20, s20, s29
    s_add_u32 s16, s20, 1835008
    s_mov_b32 s84, s16
    s_add_u32 s85, s16, 16384
    s_add_u32 s86, s16, 32768
    s_add_u32 s87, s16, 49152
    s_add_u32 s16, s16, 65536
    buffer_load_dwordx4 v[40:43], v19, s[8:11], s84 offen offset:0 nt
    buffer_load_dwordx4 v[44:47], v19, s[8:11], s84 offen offset:1024 nt
    buffer_load_dwordx4 v[48:51], v19, s[8:11], s84 offen offset:2048 nt
    buffer_load_dwordx4 v[52:55], v19, s[8:11], s84 offen offset:3072 nt
    buffer_load_dwordx4 v[56:59], v19, s[8:11], s85 offen offset:0 nt
    buffer_load_dwordx4 v[60:63], v19, s[8:11], s85 offen offset:1024 nt
    v_mov_b32 v8, 0
    v_mov_b32 v9, 0
    v_mov_b32 v10, 0
    v_mov_b32 v11, 0
    v_mov_b32 v12, 0
    v_mov_b32 v13, 0
    v_mov_b32 v14, 0
    v_mov_b32 v15, 0
    v_mov_b32 v16, 0xff800000
    v_mov_b32 v17, 0
    s_mul_i32 s29, s4, 256
    s_add_u32 s29, s29, 32768
    v_mov_b32 v36, s29
    v_mov_b32 v37, 1
    v_mov_b32 v38, 0
    s_mov_b32 s27, 0x3db504f3
    v_lshlrev_b32 v248, 3, v1
    ds_write_b64 v248, v[8:9] offset:11776
    v_mov_b32 v248, 11776
    s_mov_b32 s88, 0xcccccccc
    s_mov_b32 s89, 0xcccccccc
    s_mov_b32 s90, 0xaaaaaaaa
    s_mov_b32 s91, 0xaaaaaaaa
    s_mul_i32 s29, s4, 16384
    s_add_u32 s29, s29, 4194304
    v_lshl_add_u32 v242, v1, 1, s29
    s_mul_i32 s29, s5, 512
    s_lshl_b32 s30, s3, 7
    s_add_u32 s29, s29, s30
    v_add_u32 v241, s29, v242
    s_mul_i32 s29, s3, 7168
    s_add_u32 s29, s29, 12288
    v_lshl_add_u32 v240, v1, 2, s29
    v_lshrrev_b32 v5, 4, v1
    s_lshl_b32 s29, s3, 2
    v_add_u32 v5, s29, v5
    v_lshlrev_b32 v246, 3, v5
    v_and_b32 v3, 15, v1
    v_lshlrev_b32 v3, 4, v3
    v_lshl_add_u32 v245, v5, 9, v3
    s_waitcnt vmcnt(5)
    buffer_load_dwordx4 v[64:67], v19, s[8:11], s85 offen offset:2048 nt
    s_waitcnt vmcnt(5)
    buffer_load_dwordx4 v[68:71], v19, s[8:11], s85 offen offset:3072 nt
    s_waitcnt vmcnt(5)
    buffer_load_dwordx4 v[72:75], v19, s[8:11], s86 offen offset:0 nt
    s_waitcnt vmcnt(5)
    buffer_load_dwordx4 v[76:79], v19, s[8:11], s86 offen offset:1024 nt
    s_waitcnt vmcnt(5)
    buffer_load_dwordx4 v[80:83], v19, s[8:11], s86 offen offset:2048 nt
    s_waitcnt vmcnt(5)
    buffer_load_dwordx4 v[84:87], v19, s[8:11], s86 offen offset:3072 nt
    s_waitcnt vmcnt(5)
    buffer_load_dwordx4 v[88:91], v19, s[8:11], s87 offen offset:0 nt
    s_waitcnt vmcnt(5)
    buffer_load_dwordx4 v[92:95], v19, s[8:11], s87 offen offset:1024 nt
    s_waitcnt vmcnt(5)
    buffer_load_dwordx4 v[96:99], v19, s[8:11], s87 offen offset:2048 nt
    s_waitcnt vmcnt(5)
    buffer_load_dwordx4 v[100:103], v19, s[8:11], s87 offen offset:3072 nt
    s_mov_b32 s84, s16
    s_add_u32 s85, s16, 16384
    s_add_u32 s86, s16, 32768
    s_add_u32 s87, s16, 49152
    s_add_u32 s16, s16, 65536
    s_waitcnt vmcnt(5)
    buffer_load_dwordx4 v[104:107], v19, s[8:11], s84 offen offset:0 nt
    s_waitcnt vmcnt(5)
    buffer_load_dwordx4 v[108:111], v19, s[8:11], s84 offen offset:1024 nt
    s_waitcnt vmcnt(5)
    buffer_load_dwordx4 v[112:115], v19, s[8:11], s84 offen offset:2048 nt
    s_waitcnt vmcnt(5)
    buffer_load_dwordx4 v[116:119], v19, s[8:11], s84 offen offset:3072 nt
    s_waitcnt vmcnt(5)
    buffer_load_dwordx4 v[120:123], v19, s[8:11], s85 offen offset:0 nt
    s_waitcnt vmcnt(5)
    buffer_load_dwordx4 v[124:127], v19, s[8:11], s85 offen offset:1024 nt
    s_waitcnt vmcnt(5)
    buffer_load_dwordx4 v[128:131], v19, s[8:11], s85 offen offset:2048 nt
    s_waitcnt vmcnt(5)
    buffer_load_dwordx4 v[132:135], v19, s[8:11], s85 offen offset:3072 nt
    s_waitcnt vmcnt(5)
    buffer_load_dwordx4 v[136:139], v19, s[8:11], s86 offen offset:0 nt
    s_waitcnt vmcnt(5)
    buffer_load_dwordx4 v[140:143], v19, s[8:11], s86 offen offset:1024 nt
    s_waitcnt vmcnt(5)
    buffer_load_dwordx4 v[144:147], v19, s[8:11], s86 offen offset:2048 nt
    s_waitcnt vmcnt(5)
    buffer_load_dwordx4 v[148:151], v19, s[8:11], s86 offen offset:3072 nt
    s_waitcnt vmcnt(5)
    buffer_load_dwordx4 v[152:155], v19, s[8:11], s87 offen offset:0 nt
    s_waitcnt vmcnt(5)
    buffer_load_dwordx4 v[156:159], v19, s[8:11], s87 offen offset:1024 nt
    s_waitcnt vmcnt(5)
    buffer_load_dwordx4 v[160:163], v19, s[8:11], s87 offen offset:2048 nt
    s_waitcnt vmcnt(5)
    buffer_load_dwordx4 v[164:167], v19, s[8:11], s87 offen offset:3072 nt
    s_mov_b32 s84, s16
    s_add_u32 s85, s16, 16384
    s_add_u32 s86, s16, 32768
    s_add_u32 s87, s16, 49152
    s_add_u32 s16, s16, 65536
    s_waitcnt vmcnt(5)
    buffer_load_dwordx4 v[168:171], v19, s[8:11], s84 offen offset:0 nt
    s_waitcnt vmcnt(5)
    buffer_load_dwordx4 v[172:175], v19, s[8:11], s84 offen offset:1024 nt
    s_waitcnt vmcnt(5)
    buffer_load_dwordx4 v[176:179], v19, s[8:11], s84 offen offset:2048 nt
    s_waitcnt vmcnt(5)
    buffer_load_dwordx4 v[180:183], v19, s[8:11], s84 offen offset:3072 nt
    s_waitcnt vmcnt(5)
    buffer_load_dwordx4 v[184:187], v19, s[8:11], s85 offen offset:0 nt
    s_waitcnt vmcnt(5)
    buffer_load_dwordx4 v[188:191], v19, s[8:11], s85 offen offset:1024 nt
    s_waitcnt vmcnt(5)
    buffer_load_dwordx4 v[192:195], v19, s[8:11], s85 offen offset:2048 nt
    s_waitcnt vmcnt(5)
    buffer_load_dwordx4 v[196:199], v19, s[8:11], s85 offen offset:3072 nt
    s_waitcnt vmcnt(5)
    buffer_load_dwordx4 v[200:203], v19, s[8:11], s86 offen offset:0 nt
    s_waitcnt vmcnt(5)
    buffer_load_dwordx4 v[204:207], v19, s[8:11], s86 offen offset:1024 nt
    s_waitcnt vmcnt(5)
    buffer_load_dwordx4 v[208:211], v19, s[8:11], s86 offen offset:2048 nt
    s_waitcnt vmcnt(5)
    buffer_load_dwordx4 v[212:215], v19, s[8:11], s86 offen offset:3072 nt
    s_waitcnt vmcnt(5)
    buffer_load_dwordx4 v[216:219], v19, s[8:11], s87 offen offset:0 nt
    s_waitcnt vmcnt(5)
    buffer_load_dwordx4 v[220:223], v19, s[8:11], s87 offen offset:1024 nt
    s_waitcnt vmcnt(5)
    buffer_load_dwordx4 v[224:227], v19, s[8:11], s87 offen offset:2048 nt
    s_waitcnt vmcnt(5)
    buffer_load_dwordx4 v[228:231], v19, s[8:11], s87 offen offset:3072 nt
    s_mov_b32 s84, s16
    s_add_u32 s85, s16, 16384
    s_add_u32 s86, s16, 32768
    s_add_u32 s87, s16, 49152
    s_waitcnt lgkmcnt(0)
    s_barrier
    ds_read_b128 v[232:235], v3 offset:8448
    s_waitcnt vmcnt(5) lgkmcnt(0)
    v_dot2_f32_bf16 v20, v40, v232, 0
    v_dot2_f32_bf16 v20, v41, v233, v20
    v_dot2_f32_bf16 v20, v42, v234, v20
    v_dot2_f32_bf16 v20, v43, v235, v20
    s_waitcnt vmcnt(5)
    buffer_load_dwordx4 v[40:43], v19, s[8:11], s84 offen offset:0 nt
    v_dot2_f32_bf16 v21, v44, v232, 0
    v_dot2_f32_bf16 v21, v45, v233, v21
    v_dot2_f32_bf16 v21, v46, v234, v21
    v_dot2_f32_bf16 v21, v47, v235, v21
    s_waitcnt vmcnt(5)
    buffer_load_dwordx4 v[44:47], v19, s[8:11], s84 offen offset:1024 nt
    v_dot2_f32_bf16 v22, v48, v232, 0
    v_dot2_f32_bf16 v22, v49, v233, v22
    v_dot2_f32_bf16 v22, v50, v234, v22
    v_dot2_f32_bf16 v22, v51, v235, v22
    s_waitcnt vmcnt(5)
    buffer_load_dwordx4 v[48:51], v19, s[8:11], s84 offen offset:2048 nt
    v_dot2_f32_bf16 v23, v52, v232, 0
    v_dot2_f32_bf16 v23, v53, v233, v23
    v_dot2_f32_bf16 v23, v54, v234, v23
    v_dot2_f32_bf16 v23, v55, v235, v23
    s_waitcnt vmcnt(5)
    buffer_load_dwordx4 v[52:55], v19, s[8:11], s84 offen offset:3072 nt
    v_dot2_f32_bf16 v24, v56, v232, 0
    v_dot2_f32_bf16 v24, v57, v233, v24
    v_dot2_f32_bf16 v24, v58, v234, v24
    v_dot2_f32_bf16 v24, v59, v235, v24
    s_waitcnt vmcnt(5)
    buffer_load_dwordx4 v[56:59], v19, s[8:11], s85 offen offset:0 nt
    v_dot2_f32_bf16 v25, v60, v232, 0
    v_dot2_f32_bf16 v25, v61, v233, v25
    v_dot2_f32_bf16 v25, v62, v234, v25
    v_dot2_f32_bf16 v25, v63, v235, v25
    s_waitcnt vmcnt(5)
    buffer_load_dwordx4 v[60:63], v19, s[8:11], s85 offen offset:1024 nt
    v_dot2_f32_bf16 v26, v64, v232, 0
    v_dot2_f32_bf16 v26, v65, v233, v26
    v_dot2_f32_bf16 v26, v66, v234, v26
    v_dot2_f32_bf16 v26, v67, v235, v26
    v_dot2_f32_bf16 v27, v68, v232, 0
    v_dot2_f32_bf16 v27, v69, v233, v27
    v_dot2_f32_bf16 v27, v70, v234, v27
    v_dot2_f32_bf16 v27, v71, v235, v27
    v_dot2_f32_bf16 v28, v72, v232, 0
    v_dot2_f32_bf16 v28, v73, v233, v28
    v_dot2_f32_bf16 v28, v74, v234, v28
    v_dot2_f32_bf16 v28, v75, v235, v28
    v_dot2_f32_bf16 v29, v76, v232, 0
    v_dot2_f32_bf16 v29, v77, v233, v29
    v_dot2_f32_bf16 v29, v78, v234, v29
    v_dot2_f32_bf16 v29, v79, v235, v29
    v_dot2_f32_bf16 v30, v80, v232, 0
    v_dot2_f32_bf16 v30, v81, v233, v30
    v_dot2_f32_bf16 v30, v82, v234, v30
    v_dot2_f32_bf16 v30, v83, v235, v30
    s_waitcnt vmcnt(5)
    buffer_load_dwordx4 v[64:67], v19, s[8:11], s85 offen offset:2048 nt
    v_dot2_f32_bf16 v31, v84, v232, 0
    v_dot2_f32_bf16 v31, v85, v233, v31
    v_dot2_f32_bf16 v31, v86, v234, v31
    v_dot2_f32_bf16 v31, v87, v235, v31
    v_dot2_f32_bf16 v32, v88, v232, 0
    v_dot2_f32_bf16 v32, v89, v233, v32
    v_dot2_f32_bf16 v32, v90, v234, v32
    v_dot2_f32_bf16 v32, v91, v235, v32
    v_dot2_f32_bf16 v33, v92, v232, 0
    v_dot2_f32_bf16 v33, v93, v233, v33
    v_dot2_f32_bf16 v33, v94, v234, v33
    v_dot2_f32_bf16 v33, v95, v235, v33
    v_dot2_f32_bf16 v34, v96, v232, 0
    v_dot2_f32_bf16 v34, v97, v233, v34
    v_dot2_f32_bf16 v34, v98, v234, v34
    v_dot2_f32_bf16 v34, v99, v235, v34
    v_dot2_f32_bf16 v35, v100, v232, 0
    v_dot2_f32_bf16 v35, v101, v233, v35
    v_dot2_f32_bf16 v35, v102, v234, v35
    v_dot2_f32_bf16 v35, v103, v235, v35
    s_waitcnt vmcnt(5)
    buffer_load_dwordx4 v[68:71], v19, s[8:11], s85 offen offset:3072 nt
    v_add_f32_dpp v20, v20, v20 row_ror:8 row_mask:0xf bank_mask:0x3
    v_add_f32_dpp v21, v21, v21 row_ror:8 row_mask:0xf bank_mask:0x3
    v_add_f32_dpp v22, v22, v22 row_ror:8 row_mask:0xf bank_mask:0x3
    v_add_f32_dpp v23, v23, v23 row_ror:8 row_mask:0xf bank_mask:0x3
    v_add_f32_dpp v24, v24, v24 row_ror:8 row_mask:0xf bank_mask:0x3
    v_add_f32_dpp v25, v25, v25 row_ror:8 row_mask:0xf bank_mask:0x3
    v_add_f32_dpp v26, v26, v26 row_ror:8 row_mask:0xf bank_mask:0x3
    v_add_f32_dpp v27, v27, v27 row_ror:8 row_mask:0xf bank_mask:0x3
    v_add_f32_dpp v20, v28, v28 row_ror:8 row_mask:0xf bank_mask:0xc
    v_add_f32_dpp v21, v29, v29 row_ror:8 row_mask:0xf bank_mask:0xc
    v_add_f32_dpp v22, v30, v30 row_ror:8 row_mask:0xf bank_mask:0xc
    v_add_f32_dpp v23, v31, v31 row_ror:8 row_mask:0xf bank_mask:0xc
    v_add_f32_dpp v24, v32, v32 row_ror:8 row_mask:0xf bank_mask:0xc
    v_add_f32_dpp v25, v33, v33 row_ror:8 row_mask:0xf bank_mask:0xc
    v_add_f32_dpp v26, v34, v34 row_ror:8 row_mask:0xf bank_mask:0xc
    v_add_f32_dpp v27, v35, v35 row_ror:8 row_mask:0xf bank_mask:0xc
    v_add_f32_dpp v20, v20, v20 row_shl:4 row_mask:0xf bank_mask:0x5
    v_add_f32_dpp v21, v21, v21 row_shl:4 row_mask:0xf bank_mask:0x5
    v_add_f32_dpp v22, v22, v22 row_shl:4 row_mask:0xf bank_mask:0x5
    v_add_f32_dpp v23, v23, v23 row_shl:4 row_mask:0xf bank_mask:0x5
    v_add_f32_dpp v20, v24, v24 row_shr:4 row_mask:0xf bank_mask:0xa
    v_add_f32_dpp v21, v25, v25 row_shr:4 row_mask:0xf bank_mask:0xa
    v_add_f32_dpp v22, v26, v26 row_shr:4 row_mask:0xf bank_mask:0xa
    v_add_f32_dpp v23, v27, v27 row_shr:4 row_mask:0xf bank_mask:0xa
    v_cndmask_b32 v24, v22, v20, s[88:89]
    v_cndmask_b32 v20, v20, v22, s[88:89]
    v_cndmask_b32 v25, v23, v21, s[88:89]
    v_cndmask_b32 v21, v21, v23, s[88:89]
    v_add_f32_dpp v20, v24, v20 quad_perm:[2,3,0,1] row_mask:0xf bank_mask:0xf
    s_nop 0
    v_add_f32_dpp v21, v25, v21 quad_perm:[2,3,0,1] row_mask:0xf bank_mask:0xf
    v_cndmask_b32 v24, v21, v20, s[90:91]
    v_cndmask_b32 v20, v20, v21, s[90:91]
    s_nop 1
    v_add_f32_dpp v20, v24, v20 quad_perm:[1,0,3,2] row_mask:0xf bank_mask:0xf
    v_cvt_pk_bf16_f32 v20, 0, v20
    v_mul_f32 v20, s27, v20
    v_cvt_pk_bf16_f32 v18, 0, v20
    global_store_short_d16_hi v241, v18, s[66:67] sc1 nt
    v_add_u32 v241, 4096, v241
    v_dot2_f32_bf16 v20, v104, v232, 0
    v_dot2_f32_bf16 v20, v105, v233, v20
    v_dot2_f32_bf16 v20, v106, v234, v20
    v_dot2_f32_bf16 v20, v107, v235, v20
    v_dot2_f32_bf16 v21, v108, v232, 0
    v_dot2_f32_bf16 v21, v109, v233, v21
    v_dot2_f32_bf16 v21, v110, v234, v21
    v_dot2_f32_bf16 v21, v111, v235, v21
    v_dot2_f32_bf16 v22, v112, v232, 0
    v_dot2_f32_bf16 v22, v113, v233, v22
    v_dot2_f32_bf16 v22, v114, v234, v22
    v_dot2_f32_bf16 v22, v115, v235, v22
    v_dot2_f32_bf16 v23, v116, v232, 0
    v_dot2_f32_bf16 v23, v117, v233, v23
    v_dot2_f32_bf16 v23, v118, v234, v23
    v_dot2_f32_bf16 v23, v119, v235, v23
    s_waitcnt vmcnt(5)
    buffer_load_dwordx4 v[72:75], v19, s[8:11], s86 offen offset:0 nt
    v_dot2_f32_bf16 v24, v120, v232, 0
    v_dot2_f32_bf16 v24, v121, v233, v24
    v_dot2_f32_bf16 v24, v122, v234, v24
    v_dot2_f32_bf16 v24, v123, v235, v24
    v_dot2_f32_bf16 v25, v124, v232, 0
    v_dot2_f32_bf16 v25, v125, v233, v25
    v_dot2_f32_bf16 v25, v126, v234, v25
    v_dot2_f32_bf16 v25, v127, v235, v25
    v_dot2_f32_bf16 v26, v128, v232, 0
    v_dot2_f32_bf16 v26, v129, v233, v26
    v_dot2_f32_bf16 v26, v130, v234, v26
    v_dot2_f32_bf16 v26, v131, v235, v26
    v_dot2_f32_bf16 v27, v132, v232, 0
    v_dot2_f32_bf16 v27, v133, v233, v27
    v_dot2_f32_bf16 v27, v134, v234, v27
    v_dot2_f32_bf16 v27, v135, v235, v27
    s_waitcnt vmcnt(5)
    buffer_load_dwordx4 v[76:79], v19, s[8:11], s86 offen offset:1024 nt
    v_dot2_f32_bf16 v28, v136, v232, 0
    v_dot2_f32_bf16 v28, v137, v233, v28
    v_dot2_f32_bf16 v28, v138, v234, v28
    v_dot2_f32_bf16 v28, v139, v235, v28
    v_dot2_f32_bf16 v29, v140, v232, 0
    v_dot2_f32_bf16 v29, v141, v233, v29
    v_dot2_f32_bf16 v29, v142, v234, v29
    v_dot2_f32_bf16 v29, v143, v235, v29
    v_dot2_f32_bf16 v30, v144, v232, 0
    v_dot2_f32_bf16 v30, v145, v233, v30
    v_dot2_f32_bf16 v30, v146, v234, v30
    v_dot2_f32_bf16 v30, v147, v235, v30
    v_dot2_f32_bf16 v31, v148, v232, 0
    v_dot2_f32_bf16 v31, v149, v233, v31
    v_dot2_f32_bf16 v31, v150, v234, v31
    v_dot2_f32_bf16 v31, v151, v235, v31
    s_waitcnt vmcnt(5)
    buffer_load_dwordx4 v[80:83], v19, s[8:11], s86 offen offset:2048 nt
    v_dot2_f32_bf16 v32, v152, v232, 0
    v_dot2_f32_bf16 v32, v153, v233, v32
    v_dot2_f32_bf16 v32, v154, v234, v32
    v_dot2_f32_bf16 v32, v155, v235, v32
    v_dot2_f32_bf16 v33, v156, v232, 0
    v_dot2_f32_bf16 v33, v157, v233, v33
    v_dot2_f32_bf16 v33, v158, v234, v33
    v_dot2_f32_bf16 v33, v159, v235, v33
    v_dot2_f32_bf16 v34, v160, v232, 0
    v_dot2_f32_bf16 v34, v161, v233, v34
    v_dot2_f32_bf16 v34, v162, v234, v34
    v_dot2_f32_bf16 v34, v163, v235, v34
    v_dot2_f32_bf16 v35, v164, v232, 0
    v_dot2_f32_bf16 v35, v165, v233, v35
    v_dot2_f32_bf16 v35, v166, v234, v35
    v_dot2_f32_bf16 v35, v167, v235, v35
    s_waitcnt vmcnt(5)
    buffer_load_dwordx4 v[84:87], v19, s[8:11], s86 offen offset:3072 nt
    v_add_f32_dpp v20, v20, v20 row_ror:8 row_mask:0xf bank_mask:0x3
    v_add_f32_dpp v21, v21, v21 row_ror:8 row_mask:0xf bank_mask:0x3
    v_add_f32_dpp v22, v22, v22 row_ror:8 row_mask:0xf bank_mask:0x3
    v_add_f32_dpp v23, v23, v23 row_ror:8 row_mask:0xf bank_mask:0x3
    v_add_f32_dpp v24, v24, v24 row_ror:8 row_mask:0xf bank_mask:0x3
    v_add_f32_dpp v25, v25, v25 row_ror:8 row_mask:0xf bank_mask:0x3
    v_add_f32_dpp v26, v26, v26 row_ror:8 row_mask:0xf bank_mask:0x3
    v_add_f32_dpp v27, v27, v27 row_ror:8 row_mask:0xf bank_mask:0x3
    v_add_f32_dpp v20, v28, v28 row_ror:8 row_mask:0xf bank_mask:0xc
    v_add_f32_dpp v21, v29, v29 row_ror:8 row_mask:0xf bank_mask:0xc
    v_add_f32_dpp v22, v30, v30 row_ror:8 row_mask:0xf bank_mask:0xc
    v_add_f32_dpp v23, v31, v31 row_ror:8 row_mask:0xf bank_mask:0xc
    v_add_f32_dpp v24, v32, v32 row_ror:8 row_mask:0xf bank_mask:0xc
    v_add_f32_dpp v25, v33, v33 row_ror:8 row_mask:0xf bank_mask:0xc
    v_add_f32_dpp v26, v34, v34 row_ror:8 row_mask:0xf bank_mask:0xc
    v_add_f32_dpp v27, v35, v35 row_ror:8 row_mask:0xf bank_mask:0xc
    v_add_f32_dpp v20, v20, v20 row_shl:4 row_mask:0xf bank_mask:0x5
    v_add_f32_dpp v21, v21, v21 row_shl:4 row_mask:0xf bank_mask:0x5
    v_add_f32_dpp v22, v22, v22 row_shl:4 row_mask:0xf bank_mask:0x5
    v_add_f32_dpp v23, v23, v23 row_shl:4 row_mask:0xf bank_mask:0x5
    v_add_f32_dpp v20, v24, v24 row_shr:4 row_mask:0xf bank_mask:0xa
    v_add_f32_dpp v21, v25, v25 row_shr:4 row_mask:0xf bank_mask:0xa
    v_add_f32_dpp v22, v26, v26 row_shr:4 row_mask:0xf bank_mask:0xa
    v_add_f32_dpp v23, v27, v27 row_shr:4 row_mask:0xf bank_mask:0xa
    v_cndmask_b32 v24, v22, v20, s[88:89]
    v_cndmask_b32 v20, v20, v22, s[88:89]
    v_cndmask_b32 v25, v23, v21, s[88:89]
    v_cndmask_b32 v21, v21, v23, s[88:89]
    v_add_f32_dpp v20, v24, v20 quad_perm:[2,3,0,1] row_mask:0xf bank_mask:0xf
    s_nop 0
    v_add_f32_dpp v21, v25, v21 quad_perm:[2,3,0,1] row_mask:0xf bank_mask:0xf
    v_cndmask_b32 v24, v21, v20, s[90:91]
    v_cndmask_b32 v20, v20, v21, s[90:91]
    s_nop 1
    v_add_f32_dpp v20, v24, v20 quad_perm:[1,0,3,2] row_mask:0xf bank_mask:0xf
    v_cvt_pk_bf16_f32 v20, 0, v20
    v_mul_f32 v20, s27, v20
    v_cvt_pk_bf16_f32 v18, 0, v20
    global_store_short_d16_hi v241, v18, s[66:67] sc1 nt
    v_add_u32 v241, 4096, v241
    v_dot2_f32_bf16 v20, v168, v232, 0
    v_dot2_f32_bf16 v20, v169, v233, v20
    v_dot2_f32_bf16 v20, v170, v234, v20
    v_dot2_f32_bf16 v20, v171, v235, v20
    v_dot2_f32_bf16 v21, v172, v232, 0
    v_dot2_f32_bf16 v21, v173, v233, v21
    v_dot2_f32_bf16 v21, v174, v234, v21
    v_dot2_f32_bf16 v21, v175, v235, v21
    v_dot2_f32_bf16 v22, v176, v232, 0
    v_dot2_f32_bf16 v22, v177, v233, v22
    v_dot2_f32_bf16 v22, v178, v234, v22
    v_dot2_f32_bf16 v22, v179, v235, v22
    v_dot2_f32_bf16 v23, v180, v232, 0
    v_dot2_f32_bf16 v23, v181, v233, v23
    v_dot2_f32_bf16 v23, v182, v234, v23
    v_dot2_f32_bf16 v23, v183, v235, v23
    s_waitcnt vmcnt(5)
    buffer_load_dwordx4 v[88:91], v19, s[8:11], s87 offen offset:0 nt
    v_dot2_f32_bf16 v24, v184, v232, 0
    v_dot2_f32_bf16 v24, v185, v233, v24
    v_dot2_f32_bf16 v24, v186, v234, v24
    v_dot2_f32_bf16 v24, v187, v235, v24
    v_dot2_f32_bf16 v25, v188, v232, 0
    v_dot2_f32_bf16 v25, v189, v233, v25
    v_dot2_f32_bf16 v25, v190, v234, v25
    v_dot2_f32_bf16 v25, v191, v235, v25
    v_dot2_f32_bf16 v26, v192, v232, 0
    v_dot2_f32_bf16 v26, v193, v233, v26
    v_dot2_f32_bf16 v26, v194, v234, v26
    v_dot2_f32_bf16 v26, v195, v235, v26
    v_dot2_f32_bf16 v27, v196, v232, 0
    v_dot2_f32_bf16 v27, v197, v233, v27
    v_dot2_f32_bf16 v27, v198, v234, v27
    v_dot2_f32_bf16 v27, v199, v235, v27
    s_waitcnt vmcnt(5)
    buffer_load_dwordx4 v[92:95], v19, s[8:11], s87 offen offset:1024 nt
    v_dot2_f32_bf16 v28, v200, v232, 0
    v_dot2_f32_bf16 v28, v201, v233, v28
    v_dot2_f32_bf16 v28, v202, v234, v28
    v_dot2_f32_bf16 v28, v203, v235, v28
    v_dot2_f32_bf16 v29, v204, v232, 0
    v_dot2_f32_bf16 v29, v205, v233, v29
    v_dot2_f32_bf16 v29, v206, v234, v29
    v_dot2_f32_bf16 v29, v207, v235, v29
    v_dot2_f32_bf16 v30, v208, v232, 0
    v_dot2_f32_bf16 v30, v209, v233, v30
    v_dot2_f32_bf16 v30, v210, v234, v30
    v_dot2_f32_bf16 v30, v211, v235, v30
    v_dot2_f32_bf16 v31, v212, v232, 0
    v_dot2_f32_bf16 v31, v213, v233, v31
    v_dot2_f32_bf16 v31, v214, v234, v31
    v_dot2_f32_bf16 v31, v215, v235, v31
    s_waitcnt vmcnt(5)
    buffer_load_dwordx4 v[96:99], v19, s[8:11], s87 offen offset:2048 nt
    v_dot2_f32_bf16 v32, v216, v232, 0
    v_dot2_f32_bf16 v32, v217, v233, v32
    v_dot2_f32_bf16 v32, v218, v234, v32
    v_dot2_f32_bf16 v32, v219, v235, v32
    v_dot2_f32_bf16 v33, v220, v232, 0
    v_dot2_f32_bf16 v33, v221, v233, v33
    v_dot2_f32_bf16 v33, v222, v234, v33
    v_dot2_f32_bf16 v33, v223, v235, v33
    v_dot2_f32_bf16 v34, v224, v232, 0
    v_dot2_f32_bf16 v34, v225, v233, v34
    v_dot2_f32_bf16 v34, v226, v234, v34
    v_dot2_f32_bf16 v34, v227, v235, v34
    v_dot2_f32_bf16 v35, v228, v232, 0
    v_dot2_f32_bf16 v35, v229, v233, v35
    v_dot2_f32_bf16 v35, v230, v234, v35
    v_dot2_f32_bf16 v35, v231, v235, v35
    s_waitcnt vmcnt(5)
    buffer_load_dwordx4 v[100:103], v19, s[8:11], s87 offen offset:3072 nt
    v_add_f32_dpp v20, v20, v20 row_ror:8 row_mask:0xf bank_mask:0x3
    v_add_f32_dpp v21, v21, v21 row_ror:8 row_mask:0xf bank_mask:0x3
    v_add_f32_dpp v22, v22, v22 row_ror:8 row_mask:0xf bank_mask:0x3
    v_add_f32_dpp v23, v23, v23 row_ror:8 row_mask:0xf bank_mask:0x3
    v_add_f32_dpp v24, v24, v24 row_ror:8 row_mask:0xf bank_mask:0x3
    v_add_f32_dpp v25, v25, v25 row_ror:8 row_mask:0xf bank_mask:0x3
    v_add_f32_dpp v26, v26, v26 row_ror:8 row_mask:0xf bank_mask:0x3
    v_add_f32_dpp v27, v27, v27 row_ror:8 row_mask:0xf bank_mask:0x3
    v_add_f32_dpp v20, v28, v28 row_ror:8 row_mask:0xf bank_mask:0xc
    v_add_f32_dpp v21, v29, v29 row_ror:8 row_mask:0xf bank_mask:0xc
    v_add_f32_dpp v22, v30, v30 row_ror:8 row_mask:0xf bank_mask:0xc
    v_add_f32_dpp v23, v31, v31 row_ror:8 row_mask:0xf bank_mask:0xc
    v_add_f32_dpp v24, v32, v32 row_ror:8 row_mask:0xf bank_mask:0xc
    v_add_f32_dpp v25, v33, v33 row_ror:8 row_mask:0xf bank_mask:0xc
    v_add_f32_dpp v26, v34, v34 row_ror:8 row_mask:0xf bank_mask:0xc
    v_add_f32_dpp v27, v35, v35 row_ror:8 row_mask:0xf bank_mask:0xc
    v_add_f32_dpp v20, v20, v20 row_shl:4 row_mask:0xf bank_mask:0x5
    v_add_f32_dpp v21, v21, v21 row_shl:4 row_mask:0xf bank_mask:0x5
    v_add_f32_dpp v22, v22, v22 row_shl:4 row_mask:0xf bank_mask:0x5
    v_add_f32_dpp v23, v23, v23 row_shl:4 row_mask:0xf bank_mask:0x5
    v_add_f32_dpp v20, v24, v24 row_shr:4 row_mask:0xf bank_mask:0xa
    v_add_f32_dpp v21, v25, v25 row_shr:4 row_mask:0xf bank_mask:0xa
    v_add_f32_dpp v22, v26, v26 row_shr:4 row_mask:0xf bank_mask:0xa
    v_add_f32_dpp v23, v27, v27 row_shr:4 row_mask:0xf bank_mask:0xa
    v_cndmask_b32 v24, v22, v20, s[88:89]
    v_cndmask_b32 v20, v20, v22, s[88:89]
    v_cndmask_b32 v25, v23, v21, s[88:89]
    v_cndmask_b32 v21, v21, v23, s[88:89]
    v_add_f32_dpp v20, v24, v20 quad_perm:[2,3,0,1] row_mask:0xf bank_mask:0xf
    s_nop 0
    v_add_f32_dpp v21, v25, v21 quad_perm:[2,3,0,1] row_mask:0xf bank_mask:0xf
    v_cndmask_b32 v24, v21, v20, s[90:91]
    v_cndmask_b32 v20, v20, v21, s[90:91]
    s_nop 1
    v_add_f32_dpp v20, v24, v20 quad_perm:[1,0,3,2] row_mask:0xf bank_mask:0xf
    v_cvt_pk_bf16_f32 v20, 0, v20
    v_mul_f32 v20, s27, v20
    v_cvt_pk_bf16_f32 v18, 0, v20
    global_store_short_d16_hi v241, v18, s[66:67] sc1 nt
    v_add_u32 v241, 4096, v241
    s_mov_b32 s17, 4
    s_mov_b32 s33, 0
    v_mov_b32 v39, 0
    s_mov_b32 s16, s20
    s_nop 3
.p2align 3
L_kloop:
    s_mov_b32 s84, s16
    s_add_u32 s85, s16, 16384
    s_add_u32 s86, s16, 32768
    s_add_u32 s87, s16, 49152
    s_waitcnt vmcnt(5)
    v_dot2_f32_bf16 v20, v40, v232, 0
    v_dot2_f32_bf16 v20, v41, v233, v20
    v_dot2_f32_bf16 v20, v42, v234, v20
    v_dot2_f32_bf16 v20, v43, v235, v20
    buffer_load_dwordx4 v[40:43], v19, s[8:11], s84 offen offset:0 nt
    s_waitcnt vmcnt(5)
    v_dot2_f32_bf16 v21, v44, v232, 0
    v_dot2_f32_bf16 v21, v45, v233, v21
    v_dot2_f32_bf16 v21, v46, v234, v21
    v_dot2_f32_bf16 v21, v47, v235, v21
    buffer_load_dwordx4 v[44:47], v19, s[8:11], s84 offen offset:1024 nt
    s_waitcnt vmcnt(5)
    v_dot2_f32_bf16 v22, v48, v232, 0
    v_dot2_f32_bf16 v22, v49, v233, v22
    v_dot2_f32_bf16 v22, v50, v234, v22
    v_dot2_f32_bf16 v22, v51, v235, v22
    buffer_load_dwordx4 v[48:51], v19, s[8:11], s84 offen offset:2048 nt
    s_waitcnt vmcnt(5)
    v_dot2_f32_bf16 v23, v52, v232, 0
    v_dot2_f32_bf16 v23, v53, v233, v23
    v_dot2_f32_bf16 v23, v54, v234, v23
    v_dot2_f32_bf16 v23, v55, v235, v23
    buffer_load_dwordx4 v[52:55], v19, s[8:11], s84 offen offset:3072 nt
    s_waitcnt vmcnt(5)
    v_dot2_f32_bf16 v24, v56, v232, 0
    v_dot2_f32_bf16 v24, v57, v233, v24
    v_dot2_f32_bf16 v24, v58, v234, v24
    v_dot2_f32_bf16 v24, v59, v235, v24
    buffer_load_dwordx4 v[56:59], v19, s[8:11], s85 offen offset:0 nt
    s_waitcnt vmcnt(5)
    v_dot2_f32_bf16 v25, v60, v232, 0
    v_dot2_f32_bf16 v25, v61, v233, v25
    v_dot2_f32_bf16 v25, v62, v234, v25
    v_dot2_f32_bf16 v25, v63, v235, v25
    buffer_load_dwordx4 v[60:63], v19, s[8:11], s85 offen offset:1024 nt
    s_waitcnt vmcnt(5)
    v_dot2_f32_bf16 v26, v64, v232, 0
    v_dot2_f32_bf16 v26, v65, v233, v26
    v_dot2_f32_bf16 v26, v66, v234, v26
    v_dot2_f32_bf16 v26, v67, v235, v26
    buffer_load_dwordx4 v[64:67], v19, s[8:11], s85 offen offset:2048 nt
    s_waitcnt vmcnt(5)
    v_dot2_f32_bf16 v27, v68, v232, 0
    v_dot2_f32_bf16 v27, v69, v233, v27
    v_dot2_f32_bf16 v27, v70, v234, v27
    v_dot2_f32_bf16 v27, v71, v235, v27
    buffer_load_dwordx4 v[68:71], v19, s[8:11], s85 offen offset:3072 nt
    s_waitcnt vmcnt(5)
    v_dot2_f32_bf16 v28, v72, v232, 0
    v_dot2_f32_bf16 v28, v73, v233, v28
    v_dot2_f32_bf16 v28, v74, v234, v28
    v_dot2_f32_bf16 v28, v75, v235, v28
    buffer_load_dwordx4 v[72:75], v19, s[8:11], s86 offen offset:0 nt
    s_waitcnt vmcnt(5)
    v_dot2_f32_bf16 v29, v76, v232, 0
    v_dot2_f32_bf16 v29, v77, v233, v29
    v_dot2_f32_bf16 v29, v78, v234, v29
    v_dot2_f32_bf16 v29, v79, v235, v29
    buffer_load_dwordx4 v[76:79], v19, s[8:11], s86 offen offset:1024 nt
    s_waitcnt vmcnt(5)
    v_dot2_f32_bf16 v30, v80, v232, 0
    v_dot2_f32_bf16 v30, v81, v233, v30
    v_dot2_f32_bf16 v30, v82, v234, v30
    v_dot2_f32_bf16 v30, v83, v235, v30
    buffer_load_dwordx4 v[80:83], v19, s[8:11], s86 offen offset:2048 nt
    s_waitcnt vmcnt(5)
    v_dot2_f32_bf16 v31, v84, v232, 0
    v_dot2_f32_bf16 v31, v85, v233, v31
    v_dot2_f32_bf16 v31, v86, v234, v31
    v_dot2_f32_bf16 v31, v87, v235, v31
    buffer_load_dwordx4 v[84:87], v19, s[8:11], s86 offen offset:3072 nt
    s_waitcnt vmcnt(5)
    v_dot2_f32_bf16 v32, v88, v232, 0
    v_dot2_f32_bf16 v32, v89, v233, v32
    v_dot2_f32_bf16 v32, v90, v234, v32
    v_dot2_f32_bf16 v32, v91, v235, v32
    buffer_load_dwordx4 v[88:91], v19, s[8:11], s87 offen offset:0 nt
    s_waitcnt vmcnt(5)
    v_dot2_f32_bf16 v33, v92, v232, 0
    v_dot2_f32_bf16 v33, v93, v233, v33
    v_dot2_f32_bf16 v33, v94, v234, v33
    v_dot2_f32_bf16 v33, v95, v235, v33
    buffer_load_dwordx4 v[92:95], v19, s[8:11], s87 offen offset:1024 nt
    s_waitcnt vmcnt(5)
    v_dot2_f32_bf16 v34, v96, v232, 0
    v_dot2_f32_bf16 v34, v97, v233, v34
    v_dot2_f32_bf16 v34, v98, v234, v34
    v_dot2_f32_bf16 v34, v99, v235, v34
    buffer_load_dwordx4 v[96:99], v19, s[8:11], s87 offen offset:2048 nt
    s_waitcnt vmcnt(5)
    v_dot2_f32_bf16 v35, v100, v232, 0
    v_dot2_f32_bf16 v35, v101, v233, v35
    v_dot2_f32_bf16 v35, v102, v234, v35
    v_dot2_f32_bf16 v35, v103, v235, v35
    buffer_load_dwordx4 v[100:103], v19, s[8:11], s87 offen offset:3072 nt
    v_add_f32_dpp v20, v20, v20 row_ror:8 row_mask:0xf bank_mask:0x3
    v_add_f32_dpp v21, v21, v21 row_ror:8 row_mask:0xf bank_mask:0x3
    v_add_f32_dpp v22, v22, v22 row_ror:8 row_mask:0xf bank_mask:0x3
    v_add_f32_dpp v23, v23, v23 row_ror:8 row_mask:0xf bank_mask:0x3
    v_add_f32_dpp v24, v24, v24 row_ror:8 row_mask:0xf bank_mask:0x3
    v_add_f32_dpp v25, v25, v25 row_ror:8 row_mask:0xf bank_mask:0x3
    v_add_f32_dpp v26, v26, v26 row_ror:8 row_mask:0xf bank_mask:0x3
    v_add_f32_dpp v27, v27, v27 row_ror:8 row_mask:0xf bank_mask:0x3
    v_add_f32_dpp v20, v28, v28 row_ror:8 row_mask:0xf bank_mask:0xc
    v_add_f32_dpp v21, v29, v29 row_ror:8 row_mask:0xf bank_mask:0xc
    v_add_f32_dpp v22, v30, v30 row_ror:8 row_mask:0xf bank_mask:0xc
    v_add_f32_dpp v23, v31, v31 row_ror:8 row_mask:0xf bank_mask:0xc
    v_add_f32_dpp v24, v32, v32 row_ror:8 row_mask:0xf bank_mask:0xc
    v_add_f32_dpp v25, v33, v33 row_ror:8 row_mask:0xf bank_mask:0xc
    v_add_f32_dpp v26, v34, v34 row_ror:8 row_mask:0xf bank_mask:0xc
    v_add_f32_dpp v27, v35, v35 row_ror:8 row_mask:0xf bank_mask:0xc
    v_add_f32_dpp v20, v20, v20 row_shl:4 row_mask:0xf bank_mask:0x5
    v_add_f32_dpp v21, v21, v21 row_shl:4 row_mask:0xf bank_mask:0x5
    v_add_f32_dpp v22, v22, v22 row_shl:4 row_mask:0xf bank_mask:0x5
    v_add_f32_dpp v23, v23, v23 row_shl:4 row_mask:0xf bank_mask:0x5
    v_add_f32_dpp v20, v24, v24 row_shr:4 row_mask:0xf bank_mask:0xa
    v_add_f32_dpp v21, v25, v25 row_shr:4 row_mask:0xf bank_mask:0xa
    v_add_f32_dpp v22, v26, v26 row_shr:4 row_mask:0xf bank_mask:0xa
    v_add_f32_dpp v23, v27, v27 row_shr:4 row_mask:0xf bank_mask:0xa
    v_cndmask_b32 v24, v22, v20, s[88:89]
    v_cndmask_b32 v20, v20, v22, s[88:89]
    v_cndmask_b32 v25, v23, v21, s[88:89]
    v_cndmask_b32 v21, v21, v23, s[88:89]
    v_add_f32_dpp v20, v24, v20 quad_perm:[2,3,0,1] row_mask:0xf bank_mask:0xf
    s_nop 0
    v_add_f32_dpp v21, v25, v21 quad_perm:[2,3,0,1] row_mask:0xf bank_mask:0xf
    v_cndmask_b32 v24, v21, v20, s[90:91]
    v_cndmask_b32 v20, v20, v21, s[90:91]
    s_nop 1
    v_add_f32_dpp v20, v24, v20 quad_perm:[1,0,3,2] row_mask:0xf bank_mask:0xf
    v_cvt_pk_bf16_f32 v20, 0, v20
    v_mul_f32 v20, s27, v20
    v_cvt_pk_bf16_f32 v18, 0, v20
    s_cmp_le_u32 s17, 4
    s_cbranch_scc1 L_kshared
    ds_write_b32 v240, v18
    v_add_u32 v240, 256, v240
    s_sub_u32 s30, 33, s17
    s_cmp_gt_u32 s30, 10
    s_cbranch_scc1 L_nomc
    v_readfirstlane_b32 s29, v39
    s_mov_b64 exec, 1
    global_load_dword v39, v36, s[66:67] sc1
    s_mov_b64 exec, s[34:35]
    s_cmp_ge_u32 s29, 196608
    s_cselect_b32 s30, s30, 0
    s_max_u32 s33, s33, s30
L_nomc:
    s_add_u32 s16, s16, 65536
    s_add_u32 s17, s17, 1
    s_cmp_lt_u32 s17, 32
    s_cbranch_scc1 L_kloop
    s_cmp_eq_u32 s17, 32
    s_cbranch_scc0 L_vstart
    s_mov_b32 s16, s20
    s_lshl_b32 s19, s4, 24
    s_add_u32 s8, s44, s19
    s_addc_u32 s9, s45, 0
    s_branch L_kloop
L_kshared:
    global_store_short_d16_hi v241, v18, s[66:67] sc1 nt
    v_add_u32 v241, 4096, v241
    s_add_u32 s16, s16, 65536
    s_add_u32 s17, s17, 1
    s_cmp_eq_u32 s17, 4
    s_cselect_b32 s16, s20, s16
    s_branch L_kloop
L_vstart:
    v_subrev_u32 v240, 7168, v240
    ds_read_b32 v237, v240
    s_mov_b32 s17, 26
    s_mov_b32 s18, 0
    s_mov_b32 s19, 0
    s_mul_i32 s21, s4, 0
    s_and_b32 s21, s21, 0x7f
    v_mov_b32 v244, v242
    s_cmp_ge_u32 s33, 2
    s_cselect_b32 s33, s33, 0
    s_mul_i32 s33, s33, 2
    s_sub_i32 s33, 26, s33
    v_mov_b32 v20, 0x10000
    s_mov_b64 exec, 1
    ds_add_rtn_u32 v21, v248, v37 offset:256
    s_waitcnt lgkmcnt(0)
    v_cmp_eq_u32 vcc, 3, v21
    s_cbranch_vccz L_nrdy
    global_atomic_add v36, v20, s[66:67] sc1
L_nrdy:
    s_mov_b64 exec, s[34:35]
    s_nop 3
.p2align 3
L_loop:
    s_mov_b32 s84, s16
    s_add_u32 s85, s16, 16384
    s_add_u32 s86, s16, 32768
    s_add_u32 s87, s16, 49152
    s_waitcnt vmcnt(16) lgkmcnt(0)
    v_and_b32 v236, s28, v237
    s_cmp_eq_u32 s18, 0
    s_cbranch_scc1 L_stat
    v_add_u32 v244, s29, v242
    global_load_short_d16_hi v237, v244, s[66:67] sc1 nt
    s_branch L_gotsc
L_stat:
    v_add_u32 v240, 256, v240
    ds_read_b32 v237, v240
    s_cmp_gt_u32 s17, 10
    s_cbranch_scc1 L_gotsc
    v_readfirstlane_b32 s29, v39
    s_mov_b64 exec, 1
    global_load_dword v39, v36, s[66:67] sc1
    s_mov_b64 exec, s[34:35]
    s_and_b32 s29, s29, 0xffff
    s_lshl_b32 s21, s17, 3
    s_add_u32 s21, s21, s29
    s_cmp_ge_u32 s29, 4
    s_cselect_b32 s21, s21, 0
    s_nop 0
L_gotsc:
    v_max_f32 v29, v16, v236
    s_nop 1
    v_max_f32_dpp v29, v29, v29 row_ror:8 row_mask:0xf bank_mask:0xf
    s_nop 1
    v_max_f32_dpp v29, v29, v29 row_ror:4 row_mask:0xf bank_mask:0xf
    s_nop 1
    v_max_f32_dpp v29, v29, v29 row_ror:2 row_mask:0xf bank_mask:0xf
    s_nop 1
    v_max_f32_dpp v29, v29, v29 row_ror:1 row_mask:0xf bank_mask:0xf
    v_sub_f32 v30, v16, v29
    v_sub_f32 v236, v236, v29
    v_mul_f32 v30, s26, v30
    v_mul_f32 v236, s26, v236
    v_exp_f32 v30, v30
    v_exp_f32 v236, v236
    v_mov_b32 v16, v29
    v_cvt_pk_bf16_f32 v238, v236, 0
    v_cvt_pk_bf16_f32 v239, 0, v236
    v_fma_f32 v17, v17, v30, v236
    v_mul_f32 v8, v8, v30
    v_mul_f32 v9, v9, v30
    v_mul_f32 v10, v10, v30
    v_mul_f32 v11, v11, v30
    v_mul_f32 v12, v12, v30
    v_mul_f32 v13, v13, v30
    v_mul_f32 v14, v14, v30
    v_mul_f32 v15, v15, v30
    s_cmp_ge_u32 s19, 96
    s_cbranch_scc1 L_burst
    s_cmp_ge_u32 s21, 20
    s_cbranch_scc1 L_boost
    s_cmp_gt_i32 s17, s33
    s_cbranch_scc1 L_boost
    s_or_b32 s23, s17, s3
    s_cbranch_scc1 L_na_5
    s_mov_b64 exec, 1
    global_atomic_add v38, v36, v37, s[66:67] sc0 sc1
    s_mov_b64 exec, s[34:35]
L_na_5:
    s_nop 0
    s_waitcnt vmcnt(5)
    v_dot2c_f32_bf16_dpp v8, v238, v40 row_newbcast:0 row_mask:0xf bank_mask:0xf
    v_dot2c_f32_bf16_dpp v9, v239, v40 row_newbcast:0 row_mask:0xf bank_mask:0xf
    v_dot2c_f32_bf16_dpp v10, v238, v41 row_newbcast:0 row_mask:0xf bank_mask:0xf
    v_dot2c_f32_bf16_dpp v11, v239, v41 row_newbcast:0 row_mask:0xf bank_mask:0xf
    v_dot2c_f32_bf16_dpp v12, v238, v42 row_newbcast:0 row_mask:0xf bank_mask:0xf
    v_dot2c_f32_bf16_dpp v13, v239, v42 row_newbcast:0 row_mask:0xf bank_mask:0xf
    v_dot2c_f32_bf16_dpp v14, v238, v43 row_newbcast:0 row_mask:0xf bank_mask:0xf
    v_dot2c_f32_bf16_dpp v15, v239, v43 row_newbcast:0 row_mask:0xf bank_mask:0xf
    buffer_load_dwordx4 v[40:43], v19, s[8:11], s84 offen offset:0 nt
    s_waitcnt vmcnt(5)
    v_dot2c_f32_bf16_dpp v8, v238, v44 row_newbcast:1 row_mask:0xf bank_mask:0xf
    v_dot2c_f32_bf16_dpp v9, v239, v44 row_newbcast:1 row_mask:0xf bank_mask:0xf
    v_dot2c_f32_bf16_dpp v10, v238, v45 row_newbcast:1 row_mask:0xf bank_mask:0xf
    v_dot2c_f32_bf16_dpp v11, v239, v45 row_newbcast:1 row_mask:0xf bank_mask:0xf
    v_dot2c_f32_bf16_dpp v12, v238, v46 row_newbcast:1 row_mask:0xf bank_mask:0xf
    v_dot2c_f32_bf16_dpp v13, v239, v46 row_newbcast:1 row_mask:0xf bank_mask:0xf
    v_dot2c_f32_bf16_dpp v14, v238, v47 row_newbcast:1 row_mask:0xf bank_mask:0xf
    v_dot2c_f32_bf16_dpp v15, v239, v47 row_newbcast:1 row_mask:0xf bank_mask:0xf
    buffer_load_dwordx4 v[44:47], v19, s[8:11], s84 offen offset:1024 nt
    s_waitcnt vmcnt(5)
    v_dot2c_f32_bf16_dpp v8, v238, v48 row_newbcast:2 row_mask:0xf bank_mask:0xf
    v_dot2c_f32_bf16_dpp v9, v239, v48 row_newbcast:2 row_mask:0xf bank_mask:0xf
    v_dot2c_f32_bf16_dpp v10, v238, v49 row_newbcast:2 row_mask:0xf bank_mask:0xf
    v_dot2c_f32_bf16_dpp v11, v239, v49 row_newbcast:2 row_mask:0xf bank_mask:0xf
    v_dot2c_f32_bf16_dpp v12, v238, v50 row_newbcast:2 row_mask:0xf bank_mask:0xf
    v_dot2c_f32_bf16_dpp v13, v239, v50 row_newbcast:2 row_mask:0xf bank_mask:0xf
    v_dot2c_f32_bf16_dpp v14, v238, v51 row_newbcast:2 row_mask:0xf bank_mask:0xf
    v_dot2c_f32_bf16_dpp v15, v239, v51 row_newbcast:2 row_mask:0xf bank_mask:0xf
    buffer_load_dwordx4 v[48:51], v19, s[8:11], s84 offen offset:2048 nt
    s_waitcnt vmcnt(5)
    v_dot2c_f32_bf16_dpp v8, v238, v52 row_newbcast:3 row_mask:0xf bank_mask:0xf
    v_dot2c_f32_bf16_dpp v9, v239, v52 row_newbcast:3 row_mask:0xf bank_mask:0xf
    v_dot2c_f32_bf16_dpp v10, v238, v53 row_newbcast:3 row_mask:0xf bank_mask:0xf
    v_dot2c_f32_bf16_dpp v11, v239, v53 row_newbcast:3 row_mask:0xf bank_mask:0xf
    v_dot2c_f32_bf16_dpp v12, v238, v54 row_newbcast:3 row_mask:0xf bank_mask:0xf
    v_dot2c_f32_bf16_dpp v13, v239, v54 row_newbcast:3 row_mask:0xf bank_mask:0xf
    v_dot2c_f32_bf16_dpp v14, v238, v55 row_newbcast:3 row_mask:0xf bank_mask:0xf
    v_dot2c_f32_bf16_dpp v15, v239, v55 row_newbcast:3 row_mask:0xf bank_mask:0xf
    buffer_load_dwordx4 v[52:55], v19, s[8:11], s84 offen offset:3072 nt
    s_waitcnt vmcnt(5)
    v_dot2c_f32_bf16_dpp v8, v238, v56 row_newbcast:4 row_mask:0xf bank_mask:0xf
    v_dot2c_f32_bf16_dpp v9, v239, v56 row_newbcast:4 row_mask:0xf bank_mask:0xf
    v_dot2c_f32_bf16_dpp v10, v238, v57 row_newbcast:4 row_mask:0xf bank_mask:0xf
    v_dot2c_f32_bf16_dpp v11, v239, v57 row_newbcast:4 row_mask:0xf bank_mask:0xf
    v_dot2c_f32_bf16_dpp v12, v238, v58 row_newbcast:4 row_mask:0xf bank_mask:0xf
    v_dot2c_f32_bf16_dpp v13, v239, v58 row_newbcast:4 row_mask:0xf bank_mask:0xf
    v_dot2c_f32_bf16_dpp v14, v238, v59 row_newbcast:4 row_mask:0xf bank_mask:0xf
    v_dot2c_f32_bf16_dpp v15, v239, v59 row_newbcast:4 row_mask:0xf bank_mask:0xf
    buffer_load_dwordx4 v[56:59], v19, s[8:11], s85 offen offset:0 nt
    s_waitcnt vmcnt(5)
    v_dot2c_f32_bf16_dpp v8, v238, v60 row_newbcast:5 row_mask:0xf bank_mask:0xf
    v_dot2c_f32_bf16_dpp v9, v239, v60 row_newbcast:5 row_mask:0xf bank_mask:0xf
    v_dot2c_f32_bf16_dpp v10, v238, v61 row_newbcast:5 row_mask:0xf bank_mask:0xf
    v_dot2c_f32_bf16_dpp v11, v239, v61 row_newbcast:5 row_mask:0xf bank_mask:0xf
    v_dot2c_f32_bf16_dpp v12, v238, v62 row_newbcast:5 row_mask:0xf bank_mask:0xf
    v_dot2c_f32_bf16_dpp v13, v239, v62 row_newbcast:5 row_mask:0xf bank_mask:0xf
    v_dot2c_f32_bf16_dpp v14, v238, v63 row_newbcast:5 row_mask:0xf bank_mask:0xf
    v_dot2c_f32_bf16_dpp v15, v239, v63 row_newbcast:5 row_mask:0xf bank_mask:0xf
    buffer_load_dwordx4 v[60:63], v19, s[8:11], s85 offen offset:1024 nt
    s_waitcnt vmcnt(5)
    v_dot2c_f32_bf16_dpp v8, v238, v64 row_newbcast:6 row_mask:0xf bank_mask:0xf
    v_dot2c_f32_bf16_dpp v9, v239, v64 row_newbcast:6 row_mask:0xf bank_mask:0xf
    v_dot2c_f32_bf16_dpp v10, v238, v65 row_newbcast:6 row_mask:0xf bank_mask:0xf
    v_dot2c_f32_bf16_dpp v11, v239, v65 row_newbcast:6 row_mask:0xf bank_mask:0xf
    v_dot2c_f32_bf16_dpp v12, v238, v66 row_newbcast:6 row_mask:0xf bank_mask:0xf
    v_dot2c_f32_bf16_dpp v13, v239, v66 row_newbcast:6 row_mask:0xf bank_mask:0xf
    v_dot2c_f32_bf16_dpp v14, v238, v67 row_newbcast:6 row_mask:0xf bank_mask:0xf
    v_dot2c_f32_bf16_dpp v15, v239, v67 row_newbcast:6 row_mask:0xf bank_mask:0xf
    buffer_load_dwordx4 v[64:67], v19, s[8:11], s85 offen offset:2048 nt
    s_waitcnt vmcnt(5)
    v_dot2c_f32_bf16_dpp v8, v238, v68 row_newbcast:7 row_mask:0xf bank_mask:0xf
    v_dot2c_f32_bf16_dpp v9, v239, v68 row_newbcast:7 row_mask:0xf bank_mask:0xf
    v_dot2c_f32_bf16_dpp v10, v238, v69 row_newbcast:7 row_mask:0xf bank_mask:0xf
    v_dot2c_f32_bf16_dpp v11, v239, v69 row_newbcast:7 row_mask:0xf bank_mask:0xf
    v_dot2c_f32_bf16_dpp v12, v238, v70 row_newbcast:7 row_mask:0xf bank_mask:0xf
    v_dot2c_f32_bf16_dpp v13, v239, v70 row_newbcast:7 row_mask:0xf bank_mask:0xf
    v_dot2c_f32_bf16_dpp v14, v238, v71 row_newbcast:7 row_mask:0xf bank_mask:0xf
    v_dot2c_f32_bf16_dpp v15, v239, v71 row_newbcast:7 row_mask:0xf bank_mask:0xf
    buffer_load_dwordx4 v[68:71], v19, s[8:11], s85 offen offset:3072 nt
    s_cmp_lg_u32 s23, 0
    s_cbranch_scc1 L_na_6
    s_mov_b64 exec, 1
    s_waitcnt vmcnt(8)
    v_add_u32 v38, 1, v38
    ds_write_b32 v248, v38
    s_mov_b64 exec, s[34:35]
L_na_6:
    s_nop 0
    s_waitcnt vmcnt(5)
    v_dot2c_f32_bf16_dpp v8, v238, v72 row_newbcast:8 row_mask:0xf bank_mask:0xf
    v_dot2c_f32_bf16_dpp v9, v239, v72 row_newbcast:8 row_mask:0xf bank_mask:0xf
    v_dot2c_f32_bf16_dpp v10, v238, v73 row_newbcast:8 row_mask:0xf bank_mask:0xf
    v_dot2c_f32_bf16_dpp v11, v239, v73 row_newbcast:8 row_mask:0xf bank_mask:0xf
    v_dot2c_f32_bf16_dpp v12, v238, v74 row_newbcast:8 row_mask:0xf bank_mask:0xf
    v_dot2c_f32_bf16_dpp v13, v239, v74 row_newbcast:8 row_mask:0xf bank_mask:0xf
    v_dot2c_f32_bf16_dpp v14, v238, v75 row_newbcast:8 row_mask:0xf bank_mask:0xf
    v_dot2c_f32_bf16_dpp v15, v239, v75 row_newbcast:8 row_mask:0xf bank_mask:0xf
    buffer_load_dwordx4 v[72:75], v19, s[8:11], s86 offen offset:0 nt
    s_waitcnt vmcnt(5)
    v_dot2c_f32_bf16_dpp v8, v238, v76 row_newbcast:9 row_mask:0xf bank_mask:0xf
    v_dot2c_f32_bf16_dpp v9, v239, v76 row_newbcast:9 row_mask:0xf bank_mask:0xf
    v_dot2c_f32_bf16_dpp v10, v238, v77 row_newbcast:9 row_mask:0xf bank_mask:0xf
    v_dot2c_f32_bf16_dpp v11, v239, v77 row_newbcast:9 row_mask:0xf bank_mask:0xf
    v_dot2c_f32_bf16_dpp v12, v238, v78 row_newbcast:9 row_mask:0xf bank_mask:0xf
    v_dot2c_f32_bf16_dpp v13, v239, v78 row_newbcast:9 row_mask:0xf bank_mask:0xf
    v_dot2c_f32_bf16_dpp v14, v238, v79 row_newbcast:9 row_mask:0xf bank_mask:0xf
    v_dot2c_f32_bf16_dpp v15, v239, v79 row_newbcast:9 row_mask:0xf bank_mask:0xf
    buffer_load_dwordx4 v[76:79], v19, s[8:11], s86 offen offset:1024 nt
    s_waitcnt vmcnt(5)
    v_dot2c_f32_bf16_dpp v8, v238, v80 row_newbcast:10 row_mask:0xf bank_mask:0xf
    v_dot2c_f32_bf16_dpp v9, v239, v80 row_newbcast:10 row_mask:0xf bank_mask:0xf
    v_dot2c_f32_bf16_dpp v10, v238, v81 row_newbcast:10 row_mask:0xf bank_mask:0xf
    v_dot2c_f32_bf16_dpp v11, v239, v81 row_newbcast:10 row_mask:0xf bank_mask:0xf
    v_dot2c_f32_bf16_dpp v12, v238, v82 row_newbcast:10 row_mask:0xf bank_mask:0xf
    v_dot2c_f32_bf16_dpp v13, v239, v82 row_newbcast:10 row_mask:0xf bank_mask:0xf
    v_dot2c_f32_bf16_dpp v14, v238, v83 row_newbcast:10 row_mask:0xf bank_mask:0xf
    v_dot2c_f32_bf16_dpp v15, v239, v83 row_newbcast:10 row_mask:0xf bank_mask:0xf
    buffer_load_dwordx4 v[80:83], v19, s[8:11], s86 offen offset:2048 nt
    s_waitcnt vmcnt(5)
    v_dot2c_f32_bf16_dpp v8, v238, v84 row_newbcast:11 row_mask:0xf bank_mask:0xf
    v_dot2c_f32_bf16_dpp v9, v239, v84 row_newbcast:11 row_mask:0xf bank_mask:0xf
    v_dot2c_f32_bf16_dpp v10, v238, v85 row_newbcast:11 row_mask:0xf bank_mask:0xf
    v_dot2c_f32_bf16_dpp v11, v239, v85 row_newbcast:11 row_mask:0xf bank_mask:0xf
    v_dot2c_f32_bf16_dpp v12, v238, v86 row_newbcast:11 row_mask:0xf bank_mask:0xf
    v_dot2c_f32_bf16_dpp v13, v239, v86 row_newbcast:11 row_mask:0xf bank_mask:0xf
    v_dot2c_f32_bf16_dpp v14, v238, v87 row_newbcast:11 row_mask:0xf bank_mask:0xf
    v_dot2c_f32_bf16_dpp v15, v239, v87 row_newbcast:11 row_mask:0xf bank_mask:0xf
    buffer_load_dwordx4 v[84:87], v19, s[8:11], s86 offen offset:3072 nt
    s_waitcnt vmcnt(5)
    v_dot2c_f32_bf16_dpp v8, v238, v88 row_newbcast:12 row_mask:0xf bank_mask:0xf
    v_dot2c_f32_bf16_dpp v9, v239, v88 row_newbcast:12 row_mask:0xf bank_mask:0xf
    v_dot2c_f32_bf16_dpp v10, v238, v89 row_newbcast:12 row_mask:0xf bank_mask:0xf
    v_dot2c_f32_bf16_dpp v11, v239, v89 row_newbcast:12 row_mask:0xf bank_mask:0xf
    v_dot2c_f32_bf16_dpp v12, v238, v90 row_newbcast:12 row_mask:0xf bank_mask:0xf
    v_dot2c_f32_bf16_dpp v13, v239, v90 row_newbcast:12 row_mask:0xf bank_mask:0xf
    v_dot2c_f32_bf16_dpp v14, v238, v91 row_newbcast:12 row_mask:0xf bank_mask:0xf
    v_dot2c_f32_bf16_dpp v15, v239, v91 row_newbcast:12 row_mask:0xf bank_mask:0xf
    buffer_load_dwordx4 v[88:91], v19, s[8:11], s87 offen offset:0 nt
    s_waitcnt vmcnt(5)
    v_dot2c_f32_bf16_dpp v8, v238, v92 row_newbcast:13 row_mask:0xf bank_mask:0xf
    v_dot2c_f32_bf16_dpp v9, v239, v92 row_newbcast:13 row_mask:0xf bank_mask:0xf
    v_dot2c_f32_bf16_dpp v10, v238, v93 row_newbcast:13 row_mask:0xf bank_mask:0xf
    v_dot2c_f32_bf16_dpp v11, v239, v93 row_newbcast:13 row_mask:0xf bank_mask:0xf
    v_dot2c_f32_bf16_dpp v12, v238, v94 row_newbcast:13 row_mask:0xf bank_mask:0xf
    v_dot2c_f32_bf16_dpp v13, v239, v94 row_newbcast:13 row_mask:0xf bank_mask:0xf
    v_dot2c_f32_bf16_dpp v14, v238, v95 row_newbcast:13 row_mask:0xf bank_mask:0xf
    v_dot2c_f32_bf16_dpp v15, v239, v95 row_newbcast:13 row_mask:0xf bank_mask:0xf
    buffer_load_dwordx4 v[92:95], v19, s[8:11], s87 offen offset:1024 nt
    s_waitcnt vmcnt(5)
    v_dot2c_f32_bf16_dpp v8, v238, v96 row_newbcast:14 row_mask:0xf bank_mask:0xf
    v_dot2c_f32_bf16_dpp v9, v239, v96 row_newbcast:14 row_mask:0xf bank_mask:0xf
    v_dot2c_f32_bf16_dpp v10, v238, v97 row_newbcast:14 row_mask:0xf bank_mask:0xf
    v_dot2c_f32_bf16_dpp v11, v239, v97 row_newbcast:14 row_mask:0xf bank_mask:0xf
    v_dot2c_f32_bf16_dpp v12, v238, v98 row_newbcast:14 row_mask:0xf bank_mask:0xf
    v_dot2c_f32_bf16_dpp v13, v239, v98 row_newbcast:14 row_mask:0xf bank_mask:0xf
    v_dot2c_f32_bf16_dpp v14, v238, v99 row_newbcast:14 row_mask:0xf bank_mask:0xf
    v_dot2c_f32_bf16_dpp v15, v239, v99 row_newbcast:14 row_mask:0xf bank_mask:0xf
    buffer_load_dwordx4 v[96:99], v19, s[8:11], s87 offen offset:2048 nt
    s_waitcnt vmcnt(5)
    v_dot2c_f32_bf16_dpp v8, v238, v100 row_newbcast:15 row_mask:0xf bank_mask:0xf
    v_dot2c_f32_bf16_dpp v9, v239, v100 row_newbcast:15 row_mask:0xf bank_mask:0xf
    v_dot2c_f32_bf16_dpp v10, v238, v101 row_newbcast:15 row_mask:0xf bank_mask:0xf
    v_dot2c_f32_bf16_dpp v11, v239, v101 row_newbcast:15 row_mask:0xf bank_mask:0xf
    v_dot2c_f32_bf16_dpp v12, v238, v102 row_newbcast:15 row_mask:0xf bank_mask:0xf
    v_dot2c_f32_bf16_dpp v13, v239, v102 row_newbcast:15 row_mask:0xf bank_mask:0xf
    v_dot2c_f32_bf16_dpp v14, v238, v103 row_newbcast:15 row_mask:0xf bank_mask:0xf
    v_dot2c_f32_bf16_dpp v15, v239, v103 row_newbcast:15 row_mask:0xf bank_mask:0xf
    buffer_load_dwordx4 v[100:103], v19, s[8:11], s87 offen offset:3072 nt
L_vnext:
    s_cmp_eq_u32 s17, 0
    s_cbranch_scc1 L_dynnext
    s_add_u32 s16, s16, 65536
    s_sub_u32 s17, s17, 1
    s_cmp_eq_u32 s17, 0
    s_cbranch_scc0 L_loop
    s_getpc_b64 s[30:31]
    v_lshlrev_b32 v20, 7, v1
    global_load_dword v104, v20, s[30:31]
    s_branch L_loop
.p2align 3
L_boost:
    s_or_b32 s23, s17, s3
    s_cbranch_scc1 L_na_7
    s_mov_b64 exec, 1
    global_atomic_add v38, v36, v37, s[66:67] sc0 sc1
    s_mov_b64 exec, s[34:35]
L_na_7:
    s_nop 0
    s_waitcnt vmcnt(9)
    v_dot2c_f32_bf16_dpp v8, v238, v40 row_newbcast:0 row_mask:0xf bank_mask:0xf
    v_dot2c_f32_bf16_dpp v9, v239, v40 row_newbcast:0 row_mask:0xf bank_mask:0xf
    v_dot2c_f32_bf16_dpp v10, v238, v41 row_newbcast:0 row_mask:0xf bank_mask:0xf
    v_dot2c_f32_bf16_dpp v11, v239, v41 row_newbcast:0 row_mask:0xf bank_mask:0xf
    v_dot2c_f32_bf16_dpp v12, v238, v42 row_newbcast:0 row_mask:0xf bank_mask:0xf
    v_dot2c_f32_bf16_dpp v13, v239, v42 row_newbcast:0 row_mask:0xf bank_mask:0xf
    v_dot2c_f32_bf16_dpp v14, v238, v43 row_newbcast:0 row_mask:0xf bank_mask:0xf
    v_dot2c_f32_bf16_dpp v15, v239, v43 row_newbcast:0 row_mask:0xf bank_mask:0xf
    buffer_load_dwordx4 v[40:43], v19, s[8:11], s84 offen offset:0 nt
    s_waitcnt vmcnt(9)
    v_dot2c_f32_bf16_dpp v8, v238, v44 row_newbcast:1 row_mask:0xf bank_mask:0xf
    v_dot2c_f32_bf16_dpp v9, v239, v44 row_newbcast:1 row_mask:0xf bank_mask:0xf
    v_dot2c_f32_bf16_dpp v10, v238, v45 row_newbcast:1 row_mask:0xf bank_mask:0xf
    v_dot2c_f32_bf16_dpp v11, v239, v45 row_newbcast:1 row_mask:0xf bank_mask:0xf
    v_dot2c_f32_bf16_dpp v12, v238, v46 row_newbcast:1 row_mask:0xf bank_mask:0xf
    v_dot2c_f32_bf16_dpp v13, v239, v46 row_newbcast:1 row_mask:0xf bank_mask:0xf
    v_dot2c_f32_bf16_dpp v14, v238, v47 row_newbcast:1 row_mask:0xf bank_mask:0xf
    v_dot2c_f32_bf16_dpp v15, v239, v47 row_newbcast:1 row_mask:0xf bank_mask:0xf
    buffer_load_dwordx4 v[44:47], v19, s[8:11], s84 offen offset:1024 nt
    s_waitcnt vmcnt(9)
    v_dot2c_f32_bf16_dpp v8, v238, v48 row_newbcast:2 row_mask:0xf bank_mask:0xf
    v_dot2c_f32_bf16_dpp v9, v239, v48 row_newbcast:2 row_mask:0xf bank_mask:0xf
    v_dot2c_f32_bf16_dpp v10, v238, v49 row_newbcast:2 row_mask:0xf bank_mask:0xf
    v_dot2c_f32_bf16_dpp v11, v239, v49 row_newbcast:2 row_mask:0xf bank_mask:0xf
    v_dot2c_f32_bf16_dpp v12, v238, v50 row_newbcast:2 row_mask:0xf bank_mask:0xf
    v_dot2c_f32_bf16_dpp v13, v239, v50 row_newbcast:2 row_mask:0xf bank_mask:0xf
    v_dot2c_f32_bf16_dpp v14, v238, v51 row_newbcast:2 row_mask:0xf bank_mask:0xf
    v_dot2c_f32_bf16_dpp v15, v239, v51 row_newbcast:2 row_mask:0xf bank_mask:0xf
    buffer_load_dwordx4 v[48:51], v19, s[8:11], s84 offen offset:2048 nt
    s_waitcnt vmcnt(9)
    v_dot2c_f32_bf16_dpp v8, v238, v52 row_newbcast:3 row_mask:0xf bank_mask:0xf
    v_dot2c_f32_bf16_dpp v9, v239, v52 row_newbcast:3 row_mask:0xf bank_mask:0xf
    v_dot2c_f32_bf16_dpp v10, v238, v53 row_newbcast:3 row_mask:0xf bank_mask:0xf
    v_dot2c_f32_bf16_dpp v11, v239, v53 row_newbcast:3 row_mask:0xf bank_mask:0xf
    v_dot2c_f32_bf16_dpp v12, v238, v54 row_newbcast:3 row_mask:0xf bank_mask:0xf
    v_dot2c_f32_bf16_dpp v13, v239, v54 row_newbcast:3 row_mask:0xf bank_mask:0xf
    v_dot2c_f32_bf16_dpp v14, v238, v55 row_newbcast:3 row_mask:0xf bank_mask:0xf
    v_dot2c_f32_bf16_dpp v15, v239, v55 row_newbcast:3 row_mask:0xf bank_mask:0xf
    buffer_load_dwordx4 v[52:55], v19, s[8:11], s84 offen offset:3072 nt
    s_waitcnt vmcnt(9)
    v_dot2c_f32_bf16_dpp v8, v238, v56 row_newbcast:4 row_mask:0xf bank_mask:0xf
    v_dot2c_f32_bf16_dpp v9, v239, v56 row_newbcast:4 row_mask:0xf bank_mask:0xf
    v_dot2c_f32_bf16_dpp v10, v238, v57 row_newbcast:4 row_mask:0xf bank_mask:0xf
    v_dot2c_f32_bf16_dpp v11, v239, v57 row_newbcast:4 row_mask:0xf bank_mask:0xf
    v_dot2c_f32_bf16_dpp v12, v238, v58 row_newbcast:4 row_mask:0xf bank_mask:0xf
    v_dot2c_f32_bf16_dpp v13, v239, v58 row_newbcast:4 row_mask:0xf bank_mask:0xf
    v_dot2c_f32_bf16_dpp v14, v238, v59 row_newbcast:4 row_mask:0xf bank_mask:0xf
    v_dot2c_f32_bf16_dpp v15, v239, v59 row_newbcast:4 row_mask:0xf bank_mask:0xf
    buffer_load_dwordx4 v[56:59], v19, s[8:11], s85 offen offset:0 nt
    s_waitcnt vmcnt(9)
    v_dot2c_f32_bf16_dpp v8, v238, v60 row_newbcast:5 row_mask:0xf bank_mask:0xf
    v_dot2c_f32_bf16_dpp v9, v239, v60 row_newbcast:5 row_mask:0xf bank_mask:0xf
    v_dot2c_f32_bf16_dpp v10, v238, v61 row_newbcast:5 row_mask:0xf bank_mask:0xf
    v_dot2c_f32_bf16_dpp v11, v239, v61 row_newbcast:5 row_mask:0xf bank_mask:0xf
    v_dot2c_f32_bf16_dpp v12, v238, v62 row_newbcast:5 row_mask:0xf bank_mask:0xf
    v_dot2c_f32_bf16_dpp v13, v239, v62 row_newbcast:5 row_mask:0xf bank_mask:0xf
    v_dot2c_f32_bf16_dpp v14, v238, v63 row_newbcast:5 row_mask:0xf bank_mask:0xf
    v_dot2c_f32_bf16_dpp v15, v239, v63 row_newbcast:5 row_mask:0xf bank_mask:0xf
    buffer_load_dwordx4 v[60:63], v19, s[8:11], s85 offen offset:1024 nt
    s_waitcnt vmcnt(9)
    v_dot2c_f32_bf16_dpp v8, v238, v64 row_newbcast:6 row_mask:0xf bank_mask:0xf
    v_dot2c_f32_bf16_dpp v9, v239, v64 row_newbcast:6 row_mask:0xf bank_mask:0xf
    v_dot2c_f32_bf16_dpp v10, v238, v65 row_newbcast:6 row_mask:0xf bank_mask:0xf
    v_dot2c_f32_bf16_dpp v11, v239, v65 row_newbcast:6 row_mask:0xf bank_mask:0xf
    v_dot2c_f32_bf16_dpp v12, v238, v66 row_newbcast:6 row_mask:0xf bank_mask:0xf
    v_dot2c_f32_bf16_dpp v13, v239, v66 row_newbcast:6 row_mask:0xf bank_mask:0xf
    v_dot2c_f32_bf16_dpp v14, v238, v67 row_newbcast:6 row_mask:0xf bank_mask:0xf
    v_dot2c_f32_bf16_dpp v15, v239, v67 row_newbcast:6 row_mask:0xf bank_mask:0xf
    buffer_load_dwordx4 v[64:67], v19, s[8:11], s85 offen offset:2048 nt
    s_waitcnt vmcnt(9)
    v_dot2c_f32_bf16_dpp v8, v238, v68 row_newbcast:7 row_mask:0xf bank_mask:0xf
    v_dot2c_f32_bf16_dpp v9, v239, v68 row_newbcast:7 row_mask:0xf bank_mask:0xf
    v_dot2c_f32_bf16_dpp v10, v238, v69 row_newbcast:7 row_mask:0xf bank_mask:0xf
    v_dot2c_f32_bf16_dpp v11, v239, v69 row_newbcast:7 row_mask:0xf bank_mask:0xf
    v_dot2c_f32_bf16_dpp v12, v238, v70 row_newbcast:7 row_mask:0xf bank_mask:0xf
    v_dot2c_f32_bf16_dpp v13, v239, v70 row_newbcast:7 row_mask:0xf bank_mask:0xf
    v_dot2c_f32_bf16_dpp v14, v238, v71 row_newbcast:7 row_mask:0xf bank_mask:0xf
    v_dot2c_f32_bf16_dpp v15, v239, v71 row_newbcast:7 row_mask:0xf bank_mask:0xf
    buffer_load_dwordx4 v[68:71], v19, s[8:11], s85 offen offset:3072 nt
    s_cmp_lg_u32 s23, 0
    s_cbranch_scc1 L_na_8
    s_mov_b64 exec, 1
    s_waitcnt vmcnt(8)
    v_add_u32 v38, 1, v38
    ds_write_b32 v248, v38
    s_mov_b64 exec, s[34:35]
L_na_8:
    s_nop 0
    s_waitcnt vmcnt(9)
    v_dot2c_f32_bf16_dpp v8, v238, v72 row_newbcast:8 row_mask:0xf bank_mask:0xf
    v_dot2c_f32_bf16_dpp v9, v239, v72 row_newbcast:8 row_mask:0xf bank_mask:0xf
    v_dot2c_f32_bf16_dpp v10, v238, v73 row_newbcast:8 row_mask:0xf bank_mask:0xf
    v_dot2c_f32_bf16_dpp v11, v239, v73 row_newbcast:8 row_mask:0xf bank_mask:0xf
    v_dot2c_f32_bf16_dpp v12, v238, v74 row_newbcast:8 row_mask:0xf bank_mask:0xf
    v_dot2c_f32_bf16_dpp v13, v239, v74 row_newbcast:8 row_mask:0xf bank_mask:0xf
    v_dot2c_f32_bf16_dpp v14, v238, v75 row_newbcast:8 row_mask:0xf bank_mask:0xf
    v_dot2c_f32_bf16_dpp v15, v239, v75 row_newbcast:8 row_mask:0xf bank_mask:0xf
    buffer_load_dwordx4 v[72:75], v19, s[8:11], s86 offen offset:0 nt
    s_waitcnt vmcnt(9)
    v_dot2c_f32_bf16_dpp v8, v238, v76 row_newbcast:9 row_mask:0xf bank_mask:0xf
    v_dot2c_f32_bf16_dpp v9, v239, v76 row_newbcast:9 row_mask:0xf bank_mask:0xf
    v_dot2c_f32_bf16_dpp v10, v238, v77 row_newbcast:9 row_mask:0xf bank_mask:0xf
    v_dot2c_f32_bf16_dpp v11, v239, v77 row_newbcast:9 row_mask:0xf bank_mask:0xf
    v_dot2c_f32_bf16_dpp v12, v238, v78 row_newbcast:9 row_mask:0xf bank_mask:0xf
    v_dot2c_f32_bf16_dpp v13, v239, v78 row_newbcast:9 row_mask:0xf bank_mask:0xf
    v_dot2c_f32_bf16_dpp v14, v238, v79 row_newbcast:9 row_mask:0xf bank_mask:0xf
    v_dot2c_f32_bf16_dpp v15, v239, v79 row_newbcast:9 row_mask:0xf bank_mask:0xf
    buffer_load_dwordx4 v[76:79], v19, s[8:11], s86 offen offset:1024 nt
    s_waitcnt vmcnt(9)
    v_dot2c_f32_bf16_dpp v8, v238, v80 row_newbcast:10 row_mask:0xf bank_mask:0xf
    v_dot2c_f32_bf16_dpp v9, v239, v80 row_newbcast:10 row_mask:0xf bank_mask:0xf
    v_dot2c_f32_bf16_dpp v10, v238, v81 row_newbcast:10 row_mask:0xf bank_mask:0xf
    v_dot2c_f32_bf16_dpp v11, v239, v81 row_newbcast:10 row_mask:0xf bank_mask:0xf
    v_dot2c_f32_bf16_dpp v12, v238, v82 row_newbcast:10 row_mask:0xf bank_mask:0xf
    v_dot2c_f32_bf16_dpp v13, v239, v82 row_newbcast:10 row_mask:0xf bank_mask:0xf
    v_dot2c_f32_bf16_dpp v14, v238, v83 row_newbcast:10 row_mask:0xf bank_mask:0xf
    v_dot2c_f32_bf16_dpp v15, v239, v83 row_newbcast:10 row_mask:0xf bank_mask:0xf
    buffer_load_dwordx4 v[80:83], v19, s[8:11], s86 offen offset:2048 nt
    s_waitcnt vmcnt(9)
    v_dot2c_f32_bf16_dpp v8, v238, v84 row_newbcast:11 row_mask:0xf bank_mask:0xf
    v_dot2c_f32_bf16_dpp v9, v239, v84 row_newbcast:11 row_mask:0xf bank_mask:0xf
    v_dot2c_f32_bf16_dpp v10, v238, v85 row_newbcast:11 row_mask:0xf bank_mask:0xf
    v_dot2c_f32_bf16_dpp v11, v239, v85 row_newbcast:11 row_mask:0xf bank_mask:0xf
    v_dot2c_f32_bf16_dpp v12, v238, v86 row_newbcast:11 row_mask:0xf bank_mask:0xf
    v_dot2c_f32_bf16_dpp v13, v239, v86 row_newbcast:11 row_mask:0xf bank_mask:0xf
    v_dot2c_f32_bf16_dpp v14, v238, v87 row_newbcast:11 row_mask:0xf bank_mask:0xf
    v_dot2c_f32_bf16_dpp v15, v239, v87 row_newbcast:11 row_mask:0xf bank_mask:0xf
    buffer_load_dwordx4 v[84:87], v19, s[8:11], s86 offen offset:3072 nt
    s_waitcnt vmcnt(9)
    v_dot2c_f32_bf16_dpp v8, v238, v88 row_newbcast:12 row_mask:0xf bank_mask:0xf
    v_dot2c_f32_bf16_dpp v9, v239, v88 row_newbcast:12 row_mask:0xf bank_mask:0xf
    v_dot2c_f32_bf16_dpp v10, v238, v89 row_newbcast:12 row_mask:0xf bank_mask:0xf
    v_dot2c_f32_bf16_dpp v11, v239, v89 row_newbcast:12 row_mask:0xf bank_mask:0xf
    v_dot2c_f32_bf16_dpp v12, v238, v90 row_newbcast:12 row_mask:0xf bank_mask:0xf
    v_dot2c_f32_bf16_dpp v13, v239, v90 row_newbcast:12 row_mask:0xf bank_mask:0xf
    v_dot2c_f32_bf16_dpp v14, v238, v91 row_newbcast:12 row_mask:0xf bank_mask:0xf
    v_dot2c_f32_bf16_dpp v15, v239, v91 row_newbcast:12 row_mask:0xf bank_mask:0xf
    buffer_load_dwordx4 v[88:91], v19, s[8:11], s87 offen offset:0 nt
    s_waitcnt vmcnt(9)
    v_dot2c_f32_bf16_dpp v8, v238, v92 row_newbcast:13 row_mask:0xf bank_mask:0xf
    v_dot2c_f32_bf16_dpp v9, v239, v92 row_newbcast:13 row_mask:0xf bank_mask:0xf
    v_dot2c_f32_bf16_dpp v10, v238, v93 row_newbcast:13 row_mask:0xf bank_mask:0xf
    v_dot2c_f32_bf16_dpp v11, v239, v93 row_newbcast:13 row_mask:0xf bank_mask:0xf
    v_dot2c_f32_bf16_dpp v12, v238, v94 row_newbcast:13 row_mask:0xf bank_mask:0xf
    v_dot2c_f32_bf16_dpp v13, v239, v94 row_newbcast:13 row_mask:0xf bank_mask:0xf
    v_dot2c_f32_bf16_dpp v14, v238, v95 row_newbcast:13 row_mask:0xf bank_mask:0xf
    v_dot2c_f32_bf16_dpp v15, v239, v95 row_newbcast:13 row_mask:0xf bank_mask:0xf
    buffer_load_dwordx4 v[92:95], v19, s[8:11], s87 offen offset:1024 nt
    s_waitcnt vmcnt(9)
    v_dot2c_f32_bf16_dpp v8, v238, v96 row_newbcast:14 row_mask:0xf bank_mask:0xf
    v_dot2c_f32_bf16_dpp v9, v239, v96 row_newbcast:14 row_mask:0xf bank_mask:0xf
    v_dot2c_f32_bf16_dpp v10, v238, v97 row_newbcast:14 row_mask:0xf bank_mask:0xf
    v_dot2c_f32_bf16_dpp v11, v239, v97 row_newbcast:14 row_mask:0xf bank_mask:0xf
    v_dot2c_f32_bf16_dpp v12, v238, v98 row_newbcast:14 row_mask:0xf bank_mask:0xf
    v_dot2c_f32_bf16_dpp v13, v239, v98 row_newbcast:14 row_mask:0xf bank_mask:0xf
    v_dot2c_f32_bf16_dpp v14, v238, v99 row_newbcast:14 row_mask:0xf bank_mask:0xf
    v_dot2c_f32_bf16_dpp v15, v239, v99 row_newbcast:14 row_mask:0xf bank_mask:0xf
    buffer_load_dwordx4 v[96:99], v19, s[8:11], s87 offen offset:2048 nt
    s_waitcnt vmcnt(9)
    v_dot2c_f32_bf16_dpp v8, v238, v100 row_newbcast:15 row_mask:0xf bank_mask:0xf
    v_dot2c_f32_bf16_dpp v9, v239, v100 row_newbcast:15 row_mask:0xf bank_mask:0xf
    v_dot2c_f32_bf16_dpp v10, v238, v101 row_newbcast:15 row_mask:0xf bank_mask:0xf
    v_dot2c_f32_bf16_dpp v11, v239, v101 row_newbcast:15 row_mask:0xf bank_mask:0xf
    v_dot2c_f32_bf16_dpp v12, v238, v102 row_newbcast:15 row_mask:0xf bank_mask:0xf
    v_dot2c_f32_bf16_dpp v13, v239, v102 row_newbcast:15 row_mask:0xf bank_mask:0xf
    v_dot2c_f32_bf16_dpp v14, v238, v103 row_newbcast:15 row_mask:0xf bank_mask:0xf
    v_dot2c_f32_bf16_dpp v15, v239, v103 row_newbcast:15 row_mask:0xf bank_mask:0xf
    buffer_load_dwordx4 v[100:103], v19, s[8:11], s87 offen offset:3072 nt
    s_branch L_vnext
L_dynnext:
    s_mov_b32 s36, 0x100000
L_dyn2:
    ds_read_b32 v20, v248
    s_waitcnt lgkmcnt(0)
    v_readfirstlane_b32 s29, v20
    s_nop 0
    s_sub_u32 s29, s29, 1
    s_cbranch_scc0 L_dyn3
    s_sub_u32 s36, s36, 1
    s_cbranch_scc0 L_dyn2
L_dyn3:
    v_add_u32 v248, 4, v248
    s_mov_b32 s18, 1
    s_mov_b32 s21, 0
    s_mov_b32 s33, 0
    s_cmp_lt_u32 s29, 524288
    s_cbranch_scc1 L_scslow
L_scok:
    s_and_b32 s29, s29, 0xffff
    s_lshl_b32 s29, s29, 2
    s_add_u32 s29, s29, s3
    s_mov_b32 s19, s29
    s_lshr_b32 s16, s29, 5
    s_lshl_b32 s16, s16, 16
    s_and_b32 s30, s29, 28
    s_lshl_b32 s30, s30, 19
    s_add_u32 s16, s16, s30
    s_and_b32 s30, s29, 3
    s_lshl_b32 s30, s30, 12
    s_add_u32 s16, s16, s30
    s_add_u32 s16, s16, 1835008
    s_cmp_ge_u32 s29, 128
    s_cselect_b32 s16, 0x1000000, s16
    s_lshl_b32 s29, s29, 7
    s_branch L_loop
.p2align 3
L_burst:
    v_mov_b32 v30, v16
    s_nop 0
    s_lshr_b32 s23, s16, 24
    s_or_b32 s23, s23, s3
    s_cbranch_scc1 L_na_9
    s_mov_b64 exec, 1
    global_atomic_add v38, v36, v37, s[66:67] sc0 sc1
    s_mov_b64 exec, s[34:35]
L_na_9:
    s_nop 0
    s_waitcnt vmcnt(16)
    v_dot2c_f32_bf16_dpp v8, v238, v40 row_newbcast:0 row_mask:0xf bank_mask:0xf
    v_dot2c_f32_bf16_dpp v9, v239, v40 row_newbcast:0 row_mask:0xf bank_mask:0xf
    v_dot2c_f32_bf16_dpp v10, v238, v41 row_newbcast:0 row_mask:0xf bank_mask:0xf
    v_dot2c_f32_bf16_dpp v11, v239, v41 row_newbcast:0 row_mask:0xf bank_mask:0xf
    v_dot2c_f32_bf16_dpp v12, v238, v42 row_newbcast:0 row_mask:0xf bank_mask:0xf
    v_dot2c_f32_bf16_dpp v13, v239, v42 row_newbcast:0 row_mask:0xf bank_mask:0xf
    v_dot2c_f32_bf16_dpp v14, v238, v43 row_newbcast:0 row_mask:0xf bank_mask:0xf
    v_dot2c_f32_bf16_dpp v15, v239, v43 row_newbcast:0 row_mask:0xf bank_mask:0xf
    v_add_f32_dpp v31, v17, v17 row_ror:8 row_mask:0xf bank_mask:0xf
    buffer_load_dwordx4 v[40:43], v19, s[8:11], s84 offen offset:0 nt
    s_waitcnt vmcnt(16)
    v_dot2c_f32_bf16_dpp v8, v238, v44 row_newbcast:1 row_mask:0xf bank_mask:0xf
    v_dot2c_f32_bf16_dpp v9, v239, v44 row_newbcast:1 row_mask:0xf bank_mask:0xf
    v_dot2c_f32_bf16_dpp v10, v238, v45 row_newbcast:1 row_mask:0xf bank_mask:0xf
    v_dot2c_f32_bf16_dpp v11, v239, v45 row_newbcast:1 row_mask:0xf bank_mask:0xf
    v_dot2c_f32_bf16_dpp v12, v238, v46 row_newbcast:1 row_mask:0xf bank_mask:0xf
    v_dot2c_f32_bf16_dpp v13, v239, v46 row_newbcast:1 row_mask:0xf bank_mask:0xf
    v_dot2c_f32_bf16_dpp v14, v238, v47 row_newbcast:1 row_mask:0xf bank_mask:0xf
    v_dot2c_f32_bf16_dpp v15, v239, v47 row_newbcast:1 row_mask:0xf bank_mask:0xf
    v_add_f32_dpp v31, v31, v31 row_ror:4 row_mask:0xf bank_mask:0xf
    buffer_load_dwordx4 v[44:47], v19, s[8:11], s84 offen offset:1024 nt
    s_waitcnt vmcnt(16)
    v_dot2c_f32_bf16_dpp v8, v238, v48 row_newbcast:2 row_mask:0xf bank_mask:0xf
    v_dot2c_f32_bf16_dpp v9, v239, v48 row_newbcast:2 row_mask:0xf bank_mask:0xf
    v_dot2c_f32_bf16_dpp v10, v238, v49 row_newbcast:2 row_mask:0xf bank_mask:0xf
    v_dot2c_f32_bf16_dpp v11, v239, v49 row_newbcast:2 row_mask:0xf bank_mask:0xf
    v_dot2c_f32_bf16_dpp v12, v238, v50 row_newbcast:2 row_mask:0xf bank_mask:0xf
    v_dot2c_f32_bf16_dpp v13, v239, v50 row_newbcast:2 row_mask:0xf bank_mask:0xf
    v_dot2c_f32_bf16_dpp v14, v238, v51 row_newbcast:2 row_mask:0xf bank_mask:0xf
    v_dot2c_f32_bf16_dpp v15, v239, v51 row_newbcast:2 row_mask:0xf bank_mask:0xf
    v_add_f32_dpp v31, v31, v31 row_ror:2 row_mask:0xf bank_mask:0xf
    buffer_load_dwordx4 v[48:51], v19, s[8:11], s84 offen offset:2048 nt
    s_waitcnt vmcnt(16)
    v_dot2c_f32_bf16_dpp v8, v238, v52 row_newbcast:3 row_mask:0xf bank_mask:0xf
    v_dot2c_f32_bf16_dpp v9, v239, v52 row_newbcast:3 row_mask:0xf bank_mask:0xf
    v_dot2c_f32_bf16_dpp v10, v238, v53 row_newbcast:3 row_mask:0xf bank_mask:0xf
    v_dot2c_f32_bf16_dpp v11, v239, v53 row_newbcast:3 row_mask:0xf bank_mask:0xf
    v_dot2c_f32_bf16_dpp v12, v238, v54 row_newbcast:3 row_mask:0xf bank_mask:0xf
    v_dot2c_f32_bf16_dpp v13, v239, v54 row_newbcast:3 row_mask:0xf bank_mask:0xf
    v_dot2c_f32_bf16_dpp v14, v238, v55 row_newbcast:3 row_mask:0xf bank_mask:0xf
    v_dot2c_f32_bf16_dpp v15, v239, v55 row_newbcast:3 row_mask:0xf bank_mask:0xf
    v_add_f32_dpp v31, v31, v31 row_ror:1 row_mask:0xf bank_mask:0xf
    buffer_load_dwordx4 v[52:55], v19, s[8:11], s84 offen offset:3072 nt
    s_waitcnt vmcnt(16)
    v_dot2c_f32_bf16_dpp v8, v238, v56 row_newbcast:4 row_mask:0xf bank_mask:0xf
    v_dot2c_f32_bf16_dpp v9, v239, v56 row_newbcast:4 row_mask:0xf bank_mask:0xf
    v_dot2c_f32_bf16_dpp v10, v238, v57 row_newbcast:4 row_mask:0xf bank_mask:0xf
    v_dot2c_f32_bf16_dpp v11, v239, v57 row_newbcast:4 row_mask:0xf bank_mask:0xf
    v_dot2c_f32_bf16_dpp v12, v238, v58 row_newbcast:4 row_mask:0xf bank_mask:0xf
    v_dot2c_f32_bf16_dpp v13, v239, v58 row_newbcast:4 row_mask:0xf bank_mask:0xf
    v_dot2c_f32_bf16_dpp v14, v238, v59 row_newbcast:4 row_mask:0xf bank_mask:0xf
    v_dot2c_f32_bf16_dpp v15, v239, v59 row_newbcast:4 row_mask:0xf bank_mask:0xf
    buffer_load_dwordx4 v[56:59], v19, s[8:11], s85 offen offset:0 nt
    s_waitcnt vmcnt(16)
    v_dot2c_f32_bf16_dpp v8, v238, v60 row_newbcast:5 row_mask:0xf bank_mask:0xf
    v_dot2c_f32_bf16_dpp v9, v239, v60 row_newbcast:5 row_mask:0xf bank_mask:0xf
    v_dot2c_f32_bf16_dpp v10, v238, v61 row_newbcast:5 row_mask:0xf bank_mask:0xf
    v_dot2c_f32_bf16_dpp v11, v239, v61 row_newbcast:5 row_mask:0xf bank_mask:0xf
    v_dot2c_f32_bf16_dpp v12, v238, v62 row_newbcast:5 row_mask:0xf bank_mask:0xf
    v_dot2c_f32_bf16_dpp v13, v239, v62 row_newbcast:5 row_mask:0xf bank_mask:0xf
    v_dot2c_f32_bf16_dpp v14, v238, v63 row_newbcast:5 row_mask:0xf bank_mask:0xf
    v_dot2c_f32_bf16_dpp v15, v239, v63 row_newbcast:5 row_mask:0xf bank_mask:0xf
    buffer_load_dwordx4 v[60:63], v19, s[8:11], s85 offen offset:1024 nt
    s_waitcnt vmcnt(16)
    v_dot2c_f32_bf16_dpp v8, v238, v64 row_newbcast:6 row_mask:0xf bank_mask:0xf
    v_dot2c_f32_bf16_dpp v9, v239, v64 row_newbcast:6 row_mask:0xf bank_mask:0xf
    v_dot2c_f32_bf16_dpp v10, v238, v65 row_newbcast:6 row_mask:0xf bank_mask:0xf
    v_dot2c_f32_bf16_dpp v11, v239, v65 row_newbcast:6 row_mask:0xf bank_mask:0xf
    v_dot2c_f32_bf16_dpp v12, v238, v66 row_newbcast:6 row_mask:0xf bank_mask:0xf
    v_dot2c_f32_bf16_dpp v13, v239, v66 row_newbcast:6 row_mask:0xf bank_mask:0xf
    v_dot2c_f32_bf16_dpp v14, v238, v67 row_newbcast:6 row_mask:0xf bank_mask:0xf
    v_dot2c_f32_bf16_dpp v15, v239, v67 row_newbcast:6 row_mask:0xf bank_mask:0xf
    buffer_load_dwordx4 v[64:67], v19, s[8:11], s85 offen offset:2048 nt
    s_waitcnt vmcnt(16)
    v_dot2c_f32_bf16_dpp v8, v238, v68 row_newbcast:7 row_mask:0xf bank_mask:0xf
    v_dot2c_f32_bf16_dpp v9, v239, v68 row_newbcast:7 row_mask:0xf bank_mask:0xf
    v_dot2c_f32_bf16_dpp v10, v238, v69 row_newbcast:7 row_mask:0xf bank_mask:0xf
    v_dot2c_f32_bf16_dpp v11, v239, v69 row_newbcast:7 row_mask:0xf bank_mask:0xf
    v_dot2c_f32_bf16_dpp v12, v238, v70 row_newbcast:7 row_mask:0xf bank_mask:0xf
    v_dot2c_f32_bf16_dpp v13, v239, v70 row_newbcast:7 row_mask:0xf bank_mask:0xf
    v_dot2c_f32_bf16_dpp v14, v238, v71 row_newbcast:7 row_mask:0xf bank_mask:0xf
    v_dot2c_f32_bf16_dpp v15, v239, v71 row_newbcast:7 row_mask:0xf bank_mask:0xf
    buffer_load_dwordx4 v[68:71], v19, s[8:11], s85 offen offset:3072 nt
    s_cmp_lg_u32 s23, 0
    s_cbranch_scc1 L_na_10
    s_mov_b64 exec, 1
    s_waitcnt vmcnt(8)
    v_add_u32 v38, 1, v38
    ds_write_b32 v248, v38
    s_mov_b64 exec, s[34:35]
L_na_10:
    s_nop 0
    s_waitcnt vmcnt(16)
    v_dot2c_f32_bf16_dpp v8, v238, v72 row_newbcast:8 row_mask:0xf bank_mask:0xf
    v_dot2c_f32_bf16_dpp v9, v239, v72 row_newbcast:8 row_mask:0xf bank_mask:0xf
    v_dot2c_f32_bf16_dpp v10, v238, v73 row_newbcast:8 row_mask:0xf bank_mask:0xf
    v_dot2c_f32_bf16_dpp v11, v239, v73 row_newbcast:8 row_mask:0xf bank_mask:0xf
    v_dot2c_f32_bf16_dpp v12, v238, v74 row_newbcast:8 row_mask:0xf bank_mask:0xf
    v_dot2c_f32_bf16_dpp v13, v239, v74 row_newbcast:8 row_mask:0xf bank_mask:0xf
    v_dot2c_f32_bf16_dpp v14, v238, v75 row_newbcast:8 row_mask:0xf bank_mask:0xf
    v_dot2c_f32_bf16_dpp v15, v239, v75 row_newbcast:8 row_mask:0xf bank_mask:0xf
    buffer_load_dwordx4 v[72:75], v19, s[8:11], s86 offen offset:0 nt
    s_waitcnt vmcnt(16)
    v_dot2c_f32_bf16_dpp v8, v238, v76 row_newbcast:9 row_mask:0xf bank_mask:0xf
    v_dot2c_f32_bf16_dpp v9, v239, v76 row_newbcast:9 row_mask:0xf bank_mask:0xf
    v_dot2c_f32_bf16_dpp v10, v238, v77 row_newbcast:9 row_mask:0xf bank_mask:0xf
    v_dot2c_f32_bf16_dpp v11, v239, v77 row_newbcast:9 row_mask:0xf bank_mask:0xf
    v_dot2c_f32_bf16_dpp v12, v238, v78 row_newbcast:9 row_mask:0xf bank_mask:0xf
    v_dot2c_f32_bf16_dpp v13, v239, v78 row_newbcast:9 row_mask:0xf bank_mask:0xf
    v_dot2c_f32_bf16_dpp v14, v238, v79 row_newbcast:9 row_mask:0xf bank_mask:0xf
    v_dot2c_f32_bf16_dpp v15, v239, v79 row_newbcast:9 row_mask:0xf bank_mask:0xf
    buffer_load_dwordx4 v[76:79], v19, s[8:11], s86 offen offset:1024 nt
    s_waitcnt vmcnt(16)
    v_dot2c_f32_bf16_dpp v8, v238, v80 row_newbcast:10 row_mask:0xf bank_mask:0xf
    v_dot2c_f32_bf16_dpp v9, v239, v80 row_newbcast:10 row_mask:0xf bank_mask:0xf
    v_dot2c_f32_bf16_dpp v10, v238, v81 row_newbcast:10 row_mask:0xf bank_mask:0xf
    v_dot2c_f32_bf16_dpp v11, v239, v81 row_newbcast:10 row_mask:0xf bank_mask:0xf
    v_dot2c_f32_bf16_dpp v12, v238, v82 row_newbcast:10 row_mask:0xf bank_mask:0xf
    v_dot2c_f32_bf16_dpp v13, v239, v82 row_newbcast:10 row_mask:0xf bank_mask:0xf
    v_dot2c_f32_bf16_dpp v14, v238, v83 row_newbcast:10 row_mask:0xf bank_mask:0xf
    v_dot2c_f32_bf16_dpp v15, v239, v83 row_newbcast:10 row_mask:0xf bank_mask:0xf
    buffer_load_dwordx4 v[80:83], v19, s[8:11], s86 offen offset:2048 nt
    s_waitcnt vmcnt(16)
    v_dot2c_f32_bf16_dpp v8, v238, v84 row_newbcast:11 row_mask:0xf bank_mask:0xf
    v_dot2c_f32_bf16_dpp v9, v239, v84 row_newbcast:11 row_mask:0xf bank_mask:0xf
    v_dot2c_f32_bf16_dpp v10, v238, v85 row_newbcast:11 row_mask:0xf bank_mask:0xf
    v_dot2c_f32_bf16_dpp v11, v239, v85 row_newbcast:11 row_mask:0xf bank_mask:0xf
    v_dot2c_f32_bf16_dpp v12, v238, v86 row_newbcast:11 row_mask:0xf bank_mask:0xf
    v_dot2c_f32_bf16_dpp v13, v239, v86 row_newbcast:11 row_mask:0xf bank_mask:0xf
    v_dot2c_f32_bf16_dpp v14, v238, v87 row_newbcast:11 row_mask:0xf bank_mask:0xf
    v_dot2c_f32_bf16_dpp v15, v239, v87 row_newbcast:11 row_mask:0xf bank_mask:0xf
    buffer_load_dwordx4 v[84:87], v19, s[8:11], s86 offen offset:3072 nt
    s_waitcnt vmcnt(16)
    v_dot2c_f32_bf16_dpp v8, v238, v88 row_newbcast:12 row_mask:0xf bank_mask:0xf
    v_dot2c_f32_bf16_dpp v9, v239, v88 row_newbcast:12 row_mask:0xf bank_mask:0xf
    v_dot2c_f32_bf16_dpp v10, v238, v89 row_newbcast:12 row_mask:0xf bank_mask:0xf
    v_dot2c_f32_bf16_dpp v11, v239, v89 row_newbcast:12 row_mask:0xf bank_mask:0xf
    v_dot2c_f32_bf16_dpp v12, v238, v90 row_newbcast:12 row_mask:0xf bank_mask:0xf
    v_dot2c_f32_bf16_dpp v13, v239, v90 row_newbcast:12 row_mask:0xf bank_mask:0xf
    v_dot2c_f32_bf16_dpp v14, v238, v91 row_newbcast:12 row_mask:0xf bank_mask:0xf
    v_dot2c_f32_bf16_dpp v15, v239, v91 row_newbcast:12 row_mask:0xf bank_mask:0xf
    buffer_load_dwordx4 v[88:91], v19, s[8:11], s87 offen offset:0 nt
    s_waitcnt vmcnt(16)
    v_dot2c_f32_bf16_dpp v8, v238, v92 row_newbcast:13 row_mask:0xf bank_mask:0xf
    v_dot2c_f32_bf16_dpp v9, v239, v92 row_newbcast:13 row_mask:0xf bank_mask:0xf
    v_dot2c_f32_bf16_dpp v10, v238, v93 row_newbcast:13 row_mask:0xf bank_mask:0xf
    v_dot2c_f32_bf16_dpp v11, v239, v93 row_newbcast:13 row_mask:0xf bank_mask:0xf
    v_dot2c_f32_bf16_dpp v12, v238, v94 row_newbcast:13 row_mask:0xf bank_mask:0xf
    v_dot2c_f32_bf16_dpp v13, v239, v94 row_newbcast:13 row_mask:0xf bank_mask:0xf
    v_dot2c_f32_bf16_dpp v14, v238, v95 row_newbcast:13 row_mask:0xf bank_mask:0xf
    v_dot2c_f32_bf16_dpp v15, v239, v95 row_newbcast:13 row_mask:0xf bank_mask:0xf
    buffer_load_dwordx4 v[92:95], v19, s[8:11], s87 offen offset:1024 nt
    s_waitcnt vmcnt(16)
    v_dot2c_f32_bf16_dpp v8, v238, v96 row_newbcast:14 row_mask:0xf bank_mask:0xf
    v_dot2c_f32_bf16_dpp v9, v239, v96 row_newbcast:14 row_mask:0xf bank_mask:0xf
    v_dot2c_f32_bf16_dpp v10, v238, v97 row_newbcast:14 row_mask:0xf bank_mask:0xf
    v_dot2c_f32_bf16_dpp v11, v239, v97 row_newbcast:14 row_mask:0xf bank_mask:0xf
    v_dot2c_f32_bf16_dpp v12, v238, v98 row_newbcast:14 row_mask:0xf bank_mask:0xf
    v_dot2c_f32_bf16_dpp v13, v239, v98 row_newbcast:14 row_mask:0xf bank_mask:0xf
    v_dot2c_f32_bf16_dpp v14, v238, v99 row_newbcast:14 row_mask:0xf bank_mask:0xf
    v_dot2c_f32_bf16_dpp v15, v239, v99 row_newbcast:14 row_mask:0xf bank_mask:0xf
    buffer_load_dwordx4 v[96:99], v19, s[8:11], s87 offen offset:2048 nt
    s_waitcnt vmcnt(16)
    v_dot2c_f32_bf16_dpp v8, v238, v100 row_newbcast:15 row_mask:0xf bank_mask:0xf
    v_dot2c_f32_bf16_dpp v9, v239, v100 row_newbcast:15 row_mask:0xf bank_mask:0xf
    v_dot2c_f32_bf16_dpp v10, v238, v101 row_newbcast:15 row_mask:0xf bank_mask:0xf
    v_dot2c_f32_bf16_dpp v11, v239, v101 row_newbcast:15 row_mask:0xf bank_mask:0xf
    v_dot2c_f32_bf16_dpp v12, v238, v102 row_newbcast:15 row_mask:0xf bank_mask:0xf
    v_dot2c_f32_bf16_dpp v13, v239, v102 row_newbcast:15 row_mask:0xf bank_mask:0xf
    v_dot2c_f32_bf16_dpp v14, v238, v103 row_newbcast:15 row_mask:0xf bank_mask:0xf
    v_dot2c_f32_bf16_dpp v15, v239, v103 row_newbcast:15 row_mask:0xf bank_mask:0xf
    buffer_load_dwordx4 v[100:103], v19, s[8:11], s87 offen offset:3072 nt
    s_cmp_lt_u32 s16, 0x1000000
    s_cbranch_scc1 L_dynnext
    ds_write_b64 v246, v[30:31] offset:8192
    ds_write_b128 v245, v[8:11] offset:0
    ds_write_b128 v245, v[12:15] offset:256
    s_waitcnt lgkmcnt(0)
    s_endpgm
L_scslow:
    s_mov_b32 s36, 0x40000
L_scslow2:
    global_load_dword v20, v36, s[66:67] sc1
    s_waitcnt vmcnt(0)
    v_readfirstlane_b32 s30, v20
    s_nop 0
    s_cmp_ge_u32 s30, 524288
    s_cbranch_scc1 L_scok
    s_sleep 8
    s_sub_u32 s36, s36, 1
    s_cbranch_scc0 L_scslow2
    s_branch L_scok
L_service:
    s_xor_b32 s30, s4, s5
    s_and_b32 s30, s30, 3
    s_lshr_b32 s37, s4, 2
    s_mov_b32 s6, 3
    s_cmp_eq_u32 s30, 0
    s_cselect_b32 s6, 0, s6
    s_lshr_b32 s29, s5, 2
    s_add_u32 s29, s29, s30
    s_lshl_b32 s29, s29, 2
    s_add_u32 s29, s29, s30
    s_cmp_eq_u32 s29, 15
    s_cselect_b32 s6, 2, s6
    s_cselect_b32 s37, s4, s37
    s_cmp_eq_u32 s5, 7
    s_cselect_b32 s30, 2, s30
    s_lshl_b32 s29, s5, 3
    s_add_u32 s29, s29, s37
    s_cmp_eq_u32 s30, 1
    s_cselect_b32 s6, 1, s6
    s_cselect_b32 s37, s29, s37
    s_waitcnt lgkmcnt(0)
    s_mul_i32 s22, s22, 0x9e3779b1
    s_add_u32 s22, s22, 0x7f4a7c15
    s_cmp_lt_u32 s6, 2
    s_cbranch_scc1 L_sv1
    s_cmp_eq_u32 s6, 2
    s_cbranch_scc0 L_done
    s_cmp_eq_u32 s7, 1
    s_cbranch_scc0 L_done
L_sv1:
    v_mov_b32 v236, 0
    v_mov_b32 v237, 0
    v_mov_b32 v238, 0
    v_mov_b32 v239, 0
    s_waitcnt vmcnt(0)
    s_barrier
    s_cmp_eq_u32 s6, 2
    s_cbranch_scc1 L_mr
L_roles:
    v_mov_b32 v3, 0
    v_mov_b32 v4, 0
    v_mov_b32 v7, 0
    v_mov_b32 v8, 0
    v_mov_b32 v11, 0
    v_mov_b32 v54, 0
    v_mov_b32 v55, 0
    v_mov_b32 v56, 0
    v_mov_b32 v57, 0
    v_mov_b32 v59, 0
    v_mov_b32 v60, 0
    s_cmp_eq_u32 s6, 0
    s_cbranch_scc1 L_crole
    s_cmp_eq_u32 s6, 1
    s_cbranch_scc1 L_frole
    s_branch L_ready
L_done:
    s_endpgm
L_mr:
    s_lshl_b32 s17, s37, 7
    s_add_u32 s17, s17, 2048
    v_lshrrev_b32 v4, 3, v1
    v_and_b32 v6, 3, v1
    v_lshlrev_b32 v3, 7, v4
    v_lshl_add_u32 v3, v6, 4, v3
    s_mov_b32 s29, 393216
    v_mul_lo_u32 v4, v4, s29
    v_and_b32 v6, 7, v1
    v_lshl_add_u32 v4, v6, 4, v4
    v_add_u32 v4, s17, v4
    v_mov_b32 v48, 0
    v_mov_b32 v49, 0
    v_mov_b32 v50, 0
    v_mov_b32 v51, 0
    v_mov_b32 v52, 0
    v_mov_b32 v53, 0
    v_mov_b32 v54, 0
    v_mov_b32 v55, 0
    s_mov_b32 s16, 0
L_mrp:
    global_load_dwordx4 v[8:11], v3, s[58:59]
    s_waitcnt vmcnt(0)
    global_load_dwordx4 v[64:67], v4, s[60:61] nt
    v_add_u32 v4, 6144, v4
    s_waitcnt vmcnt(0)
    global_load_dwordx4 v[68:71], v4, s[60:61] nt
    v_add_u32 v4, 6144, v4
    s_waitcnt vmcnt(0)
    global_load_dwordx4 v[72:75], v4, s[60:61] nt
    v_add_u32 v4, 6144, v4
    s_waitcnt vmcnt(0)
    global_load_dwordx4 v[76:79], v4, s[60:61] nt
    v_add_u32 v4, 6144, v4
    s_waitcnt vmcnt(0)
    global_load_dwordx4 v[80:83], v4, s[60:61] nt
    v_add_u32 v4, 6144, v4
    s_waitcnt vmcnt(0)
    global_load_dwordx4 v[84:87], v4, s[60:61] nt
    v_add_u32 v4, 6144, v4
    s_waitcnt vmcnt(0)
    global_load_dwordx4 v[88:91], v4, s[60:61] nt
    v_add_u32 v4, 6144, v4
    s_waitcnt vmcnt(0)
    global_load_dwordx4 v[92:95], v4, s[60:61] nt
    v_add_u32 v4, 6144, v4
    s_waitcnt vmcnt(0)
    global_load_dwordx4 v[96:99], v4, s[60:61] nt
    v_add_u32 v4, 6144, v4
    s_waitcnt vmcnt(0)
    global_load_dwordx4 v[100:103], v4, s[60:61] nt
    v_add_u32 v4, 6144, v4
    s_waitcnt vmcnt(0)
    global_load_dwordx4 v[104:107], v4, s[60:61] nt
    v_add_u32 v4, 6144, v4
    s_waitcnt vmcnt(0)
    global_load_dwordx4 v[108:111], v4, s[60:61] nt
    v_add_u32 v4, 6144, v4
    s_waitcnt vmcnt(0)
    global_load_dwordx4 v[112:115], v4, s[60:61] nt
    v_add_u32 v4, 6144, v4
    s_waitcnt vmcnt(0)
    global_load_dwordx4 v[116:119], v4, s[60:61] nt
    v_add_u32 v4, 6144, v4
    s_waitcnt vmcnt(0)
    global_load_dwordx4 v[120:123], v4, s[60:61] nt
    v_add_u32 v4, 6144, v4
    s_waitcnt vmcnt(0)
    global_load_dwordx4 v[124:127], v4, s[60:61] nt
    v_add_u32 v4, 6144, v4
    s_waitcnt vmcnt(0)
    global_load_dwordx4 v[128:131], v4, s[60:61] nt
    v_add_u32 v4, 6144, v4
    s_waitcnt vmcnt(0)
    global_load_dwordx4 v[132:135], v4, s[60:61] nt
    v_add_u32 v4, 6144, v4
    s_waitcnt vmcnt(0)
    global_load_dwordx4 v[136:139], v4, s[60:61] nt
    v_add_u32 v4, 6144, v4
    s_waitcnt vmcnt(0)
    global_load_dwordx4 v[140:143], v4, s[60:61] nt
    v_add_u32 v4, 6144, v4
    s_waitcnt vmcnt(0)
    global_load_dwordx4 v[144:147], v4, s[60:61] nt
    v_add_u32 v4, 6144, v4
    s_waitcnt vmcnt(0)
    global_load_dwordx4 v[148:151], v4, s[60:61] nt
    v_add_u32 v4, 6144, v4
    s_waitcnt vmcnt(0)
    global_load_dwordx4 v[152:155], v4, s[60:61] nt
    v_add_u32 v4, 6144, v4
    s_waitcnt vmcnt(0)
    global_load_dwordx4 v[156:159], v4, s[60:61] nt
    v_add_u32 v4, 6144, v4
    s_waitcnt vmcnt(0)
    global_load_dwordx4 v[160:163], v4, s[60:61] nt
    v_add_u32 v4, 6144, v4
    s_waitcnt vmcnt(0)
    global_load_dwordx4 v[164:167], v4, s[60:61] nt
    v_add_u32 v4, 6144, v4
    s_waitcnt vmcnt(0)
    global_load_dwordx4 v[168:171], v4, s[60:61] nt
    v_add_u32 v4, 6144, v4
    s_waitcnt vmcnt(0)
    global_load_dwordx4 v[172:175], v4, s[60:61] nt
    v_add_u32 v4, 6144, v4
    s_waitcnt vmcnt(0)
    global_load_dwordx4 v[176:179], v4, s[60:61] nt
    v_add_u32 v4, 6144, v4
    s_waitcnt vmcnt(0)
    global_load_dwordx4 v[180:183], v4, s[60:61] nt
    v_add_u32 v4, 6144, v4
    s_waitcnt vmcnt(0)
    global_load_dwordx4 v[184:187], v4, s[60:61] nt
    v_add_u32 v4, 6144, v4
    s_waitcnt vmcnt(0)
    global_load_dwordx4 v[188:191], v4, s[60:61] nt
    v_add_u32 v4, 6144, v4
    s_waitcnt vmcnt(0)
    v_and_b32 v17, 0xffff0000, v8
    v_lshlrev_b32 v16, 16, v8
    v_and_b32 v19, 0xffff0000, v9
    v_lshlrev_b32 v18, 16, v9
    v_and_b32 v21, 0xffff0000, v10
    v_lshlrev_b32 v20, 16, v10
    v_and_b32 v23, 0xffff0000, v11
    v_lshlrev_b32 v22, 16, v11
    v_mul_f32 v24, 0xbfb8aa3b, v16
    v_mul_f32 v25, 0xbfb8aa3b, v17
    v_mul_f32 v26, 0xbfb8aa3b, v18
    v_mul_f32 v27, 0xbfb8aa3b, v19
    v_mul_f32 v28, 0xbfb8aa3b, v20
    v_mul_f32 v29, 0xbfb8aa3b, v21
    v_mul_f32 v30, 0xbfb8aa3b, v22
    v_mul_f32 v31, 0xbfb8aa3b, v23
    v_exp_f32 v24, v24
    v_exp_f32 v25, v25
    v_exp_f32 v26, v26
    v_exp_f32 v27, v27
    v_exp_f32 v28, v28
    v_exp_f32 v29, v29
    v_exp_f32 v30, v30
    v_exp_f32 v31, v31
    v_add_f32 v24, 1.0, v24
    v_add_f32 v25, 1.0, v25
    v_add_f32 v26, 1.0, v26
    v_add_f32 v27, 1.0, v27
    v_add_f32 v28, 1.0, v28
    v_add_f32 v29, 1.0, v29
    v_add_f32 v30, 1.0, v30
    v_add_f32 v31, 1.0, v31
    v_rcp_f32 v24, v24
    v_rcp_f32 v25, v25
    v_rcp_f32 v26, v26
    v_rcp_f32 v27, v27
    v_rcp_f32 v28, v28
    v_rcp_f32 v29, v29
    v_rcp_f32 v30, v30
    v_rcp_f32 v31, v31
    v_mul_f32 v16, v16, v24
    v_mul_f32 v17, v17, v25
    v_mul_f32 v18, v18, v26
    v_mul_f32 v19, v19, v27
    v_mul_f32 v20, v20, v28
    v_mul_f32 v21, v21, v29
    v_mul_f32 v22, v22, v30
    v_mul_f32 v23, v23, v31
    v_cvt_pk_bf16_f32 v32, v16, 0
    v_cvt_pk_bf16_f32 v40, 0, v16
    v_cvt_pk_bf16_f32 v33, v17, 0
    v_cvt_pk_bf16_f32 v41, 0, v17
    v_cvt_pk_bf16_f32 v34, v18, 0
    v_cvt_pk_bf16_f32 v42, 0, v18
    v_cvt_pk_bf16_f32 v35, v19, 0
    v_cvt_pk_bf16_f32 v43, 0, v19
    v_cvt_pk_bf16_f32 v36, v20, 0
    v_cvt_pk_bf16_f32 v44, 0, v20
    v_cvt_pk_bf16_f32 v37, v21, 0
    v_cvt_pk_bf16_f32 v45, 0, v21
    v_cvt_pk_bf16_f32 v38, v22, 0
    v_cvt_pk_bf16_f32 v46, 0, v22
    v_cvt_pk_bf16_f32 v39, v23, 0
    v_cvt_pk_bf16_f32 v47, 0, v23
    v_dot2c_f32_bf16_dpp v48, v32, v64 quad_perm:[0,0,0,0] row_mask:0xf bank_mask:0xf
    v_dot2c_f32_bf16_dpp v49, v40, v64 quad_perm:[0,0,0,0] row_mask:0xf bank_mask:0xf
    v_dot2c_f32_bf16_dpp v50, v32, v65 quad_perm:[0,0,0,0] row_mask:0xf bank_mask:0xf
    v_dot2c_f32_bf16_dpp v51, v40, v65 quad_perm:[0,0,0,0] row_mask:0xf bank_mask:0xf
    v_dot2c_f32_bf16_dpp v52, v32, v66 quad_perm:[0,0,0,0] row_mask:0xf bank_mask:0xf
    v_dot2c_f32_bf16_dpp v53, v40, v66 quad_perm:[0,0,0,0] row_mask:0xf bank_mask:0xf
    v_dot2c_f32_bf16_dpp v54, v32, v67 quad_perm:[0,0,0,0] row_mask:0xf bank_mask:0xf
    v_dot2c_f32_bf16_dpp v55, v40, v67 quad_perm:[0,0,0,0] row_mask:0xf bank_mask:0xf
    v_dot2c_f32_bf16_dpp v48, v33, v68 quad_perm:[0,0,0,0] row_mask:0xf bank_mask:0xf
    v_dot2c_f32_bf16_dpp v49, v41, v68 quad_perm:[0,0,0,0] row_mask:0xf bank_mask:0xf
    v_dot2c_f32_bf16_dpp v50, v33, v69 quad_perm:[0,0,0,0] row_mask:0xf bank_mask:0xf
    v_dot2c_f32_bf16_dpp v51, v41, v69 quad_perm:[0,0,0,0] row_mask:0xf bank_mask:0xf
    v_dot2c_f32_bf16_dpp v52, v33, v70 quad_perm:[0,0,0,0] row_mask:0xf bank_mask:0xf
    v_dot2c_f32_bf16_dpp v53, v41, v70 quad_perm:[0,0,0,0] row_mask:0xf bank_mask:0xf
    v_dot2c_f32_bf16_dpp v54, v33, v71 quad_perm:[0,0,0,0] row_mask:0xf bank_mask:0xf
    v_dot2c_f32_bf16_dpp v55, v41, v71 quad_perm:[0,0,0,0] row_mask:0xf bank_mask:0xf
    v_dot2c_f32_bf16_dpp v48, v34, v72 quad_perm:[0,0,0,0] row_mask:0xf bank_mask:0xf
    v_dot2c_f32_bf16_dpp v49, v42, v72 quad_perm:[0,0,0,0] row_mask:0xf bank_mask:0xf
    v_dot2c_f32_bf16_dpp v50, v34, v73 quad_perm:[0,0,0,0] row_mask:0xf bank_mask:0xf
    v_dot2c_f32_bf16_dpp v51, v42, v73 quad_perm:[0,0,0,0] row_mask:0xf bank_mask:0xf
    v_dot2c_f32_bf16_dpp v52, v34, v74 quad_perm:[0,0,0,0] row_mask:0xf bank_mask:0xf
    v_dot2c_f32_bf16_dpp v53, v42, v74 quad_perm:[0,0,0,0] row_mask:0xf bank_mask:0xf
    v_dot2c_f32_bf16_dpp v54, v34, v75 quad_perm:[0,0,0,0] row_mask:0xf bank_mask:0xf
    v_dot2c_f32_bf16_dpp v55, v42, v75 quad_perm:[0,0,0,0] row_mask:0xf bank_mask:0xf
    v_dot2c_f32_bf16_dpp v48, v35, v76 quad_perm:[0,0,0,0] row_mask:0xf bank_mask:0xf
    v_dot2c_f32_bf16_dpp v49, v43, v76 quad_perm:[0,0,0,0] row_mask:0xf bank_mask:0xf
    v_dot2c_f32_bf16_dpp v50, v35, v77 quad_perm:[0,0,0,0] row_mask:0xf bank_mask:0xf
    v_dot2c_f32_bf16_dpp v51, v43, v77 quad_perm:[0,0,0,0] row_mask:0xf bank_mask:0xf
    v_dot2c_f32_bf16_dpp v52, v35, v78 quad_perm:[0,0,0,0] row_mask:0xf bank_mask:0xf
    v_dot2c_f32_bf16_dpp v53, v43, v78 quad_perm:[0,0,0,0] row_mask:0xf bank_mask:0xf
    v_dot2c_f32_bf16_dpp v54, v35, v79 quad_perm:[0,0,0,0] row_mask:0xf bank_mask:0xf
    v_dot2c_f32_bf16_dpp v55, v43, v79 quad_perm:[0,0,0,0] row_mask:0xf bank_mask:0xf
    v_dot2c_f32_bf16_dpp v48, v36, v80 quad_perm:[0,0,0,0] row_mask:0xf bank_mask:0xf
    v_dot2c_f32_bf16_dpp v49, v44, v80 quad_perm:[0,0,0,0] row_mask:0xf bank_mask:0xf
    v_dot2c_f32_bf16_dpp v50, v36, v81 quad_perm:[0,0,0,0] row_mask:0xf bank_mask:0xf
    v_dot2c_f32_bf16_dpp v51, v44, v81 quad_perm:[0,0,0,0] row_mask:0xf bank_mask:0xf
    v_dot2c_f32_bf16_dpp v52, v36, v82 quad_perm:[0,0,0,0] row_mask:0xf bank_mask:0xf
    v_dot2c_f32_bf16_dpp v53, v44, v82 quad_perm:[0,0,0,0] row_mask:0xf bank_mask:0xf
    v_dot2c_f32_bf16_dpp v54, v36, v83 quad_perm:[0,0,0,0] row_mask:0xf bank_mask:0xf
    v_dot2c_f32_bf16_dpp v55, v44, v83 quad_perm:[0,0,0,0] row_mask:0xf bank_mask:0xf
    v_dot2c_f32_bf16_dpp v48, v37, v84 quad_perm:[0,0,0,0] row_mask:0xf bank_mask:0xf
    v_dot2c_f32_bf16_dpp v49, v45, v84 quad_perm:[0,0,0,0] row_mask:0xf bank_mask:0xf
    v_dot2c_f32_bf16_dpp v50, v37, v85 quad_perm:[0,0,0,0] row_mask:0xf bank_mask:0xf
    v_dot2c_f32_bf16_dpp v51, v45, v85 quad_perm:[0,0,0,0] row_mask:0xf bank_mask:0xf
    v_dot2c_f32_bf16_dpp v52, v37, v86 quad_perm:[0,0,0,0] row_mask:0xf bank_mask:0xf
    v_dot2c_f32_bf16_dpp v53, v45, v86 quad_perm:[0,0,0,0] row_mask:0xf bank_mask:0xf
    v_dot2c_f32_bf16_dpp v54, v37, v87 quad_perm:[0,0,0,0] row_mask:0xf bank_mask:0xf
    v_dot2c_f32_bf16_dpp v55, v45, v87 quad_perm:[0,0,0,0] row_mask:0xf bank_mask:0xf
    v_dot2c_f32_bf16_dpp v48, v38, v88 quad_perm:[0,0,0,0] row_mask:0xf bank_mask:0xf
    v_dot2c_f32_bf16_dpp v49, v46, v88 quad_perm:[0,0,0,0] row_mask:0xf bank_mask:0xf
    v_dot2c_f32_bf16_dpp v50, v38, v89 quad_perm:[0,0,0,0] row_mask:0xf bank_mask:0xf
    v_dot2c_f32_bf16_dpp v51, v46, v89 quad_perm:[0,0,0,0] row_mask:0xf bank_mask:0xf
    v_dot2c_f32_bf16_dpp v52, v38, v90 quad_perm:[0,0,0,0] row_mask:0xf bank_mask:0xf
    v_dot2c_f32_bf16_dpp v53, v46, v90 quad_perm:[0,0,0,0] row_mask:0xf bank_mask:0xf
    v_dot2c_f32_bf16_dpp v54, v38, v91 quad_perm:[0,0,0,0] row_mask:0xf bank_mask:0xf
    v_dot2c_f32_bf16_dpp v55, v46, v91 quad_perm:[0,0,0,0] row_mask:0xf bank_mask:0xf
    v_dot2c_f32_bf16_dpp v48, v39, v92 quad_perm:[0,0,0,0] row_mask:0xf bank_mask:0xf
    v_dot2c_f32_bf16_dpp v49, v47, v92 quad_perm:[0,0,0,0] row_mask:0xf bank_mask:0xf
    v_dot2c_f32_bf16_dpp v50, v39, v93 quad_perm:[0,0,0,0] row_mask:0xf bank_mask:0xf
    v_dot2c_f32_bf16_dpp v51, v47, v93 quad_perm:[0,0,0,0] row_mask:0xf bank_mask:0xf
    v_dot2c_f32_bf16_dpp v52, v39, v94 quad_perm:[0,0,0,0] row_mask:0xf bank_mask:0xf
    v_dot2c_f32_bf16_dpp v53, v47, v94 quad_perm:[0,0,0,0] row_mask:0xf bank_mask:0xf
    v_dot2c_f32_bf16_dpp v54, v39, v95 quad_perm:[0,0,0,0] row_mask:0xf bank_mask:0xf
    v_dot2c_f32_bf16_dpp v55, v47, v95 quad_perm:[0,0,0,0] row_mask:0xf bank_mask:0xf
    v_dot2c_f32_bf16_dpp v48, v32, v96 quad_perm:[1,1,1,1] row_mask:0xf bank_mask:0xf
    v_dot2c_f32_bf16_dpp v49, v40, v96 quad_perm:[1,1,1,1] row_mask:0xf bank_mask:0xf
    v_dot2c_f32_bf16_dpp v50, v32, v97 quad_perm:[1,1,1,1] row_mask:0xf bank_mask:0xf
    v_dot2c_f32_bf16_dpp v51, v40, v97 quad_perm:[1,1,1,1] row_mask:0xf bank_mask:0xf
    v_dot2c_f32_bf16_dpp v52, v32, v98 quad_perm:[1,1,1,1] row_mask:0xf bank_mask:0xf
    v_dot2c_f32_bf16_dpp v53, v40, v98 quad_perm:[1,1,1,1] row_mask:0xf bank_mask:0xf
    v_dot2c_f32_bf16_dpp v54, v32, v99 quad_perm:[1,1,1,1] row_mask:0xf bank_mask:0xf
    v_dot2c_f32_bf16_dpp v55, v40, v99 quad_perm:[1,1,1,1] row_mask:0xf bank_mask:0xf
    v_dot2c_f32_bf16_dpp v48, v33, v100 quad_perm:[1,1,1,1] row_mask:0xf bank_mask:0xf
    v_dot2c_f32_bf16_dpp v49, v41, v100 quad_perm:[1,1,1,1] row_mask:0xf bank_mask:0xf
    v_dot2c_f32_bf16_dpp v50, v33, v101 quad_perm:[1,1,1,1] row_mask:0xf bank_mask:0xf
    v_dot2c_f32_bf16_dpp v51, v41, v101 quad_perm:[1,1,1,1] row_mask:0xf bank_mask:0xf
    v_dot2c_f32_bf16_dpp v52, v33, v102 quad_perm:[1,1,1,1] row_mask:0xf bank_mask:0xf
    v_dot2c_f32_bf16_dpp v53, v41, v102 quad_perm:[1,1,1,1] row_mask:0xf bank_mask:0xf
    v_dot2c_f32_bf16_dpp v54, v33, v103 quad_perm:[1,1,1,1] row_mask:0xf bank_mask:0xf
    v_dot2c_f32_bf16_dpp v55, v41, v103 quad_perm:[1,1,1,1] row_mask:0xf bank_mask:0xf
    v_dot2c_f32_bf16_dpp v48, v34, v104 quad_perm:[1,1,1,1] row_mask:0xf bank_mask:0xf
    v_dot2c_f32_bf16_dpp v49, v42, v104 quad_perm:[1,1,1,1] row_mask:0xf bank_mask:0xf
    v_dot2c_f32_bf16_dpp v50, v34, v105 quad_perm:[1,1,1,1] row_mask:0xf bank_mask:0xf
    v_dot2c_f32_bf16_dpp v51, v42, v105 quad_perm:[1,1,1,1] row_mask:0xf bank_mask:0xf
    v_dot2c_f32_bf16_dpp v52, v34, v106 quad_perm:[1,1,1,1] row_mask:0xf bank_mask:0xf
    v_dot2c_f32_bf16_dpp v53, v42, v106 quad_perm:[1,1,1,1] row_mask:0xf bank_mask:0xf
    v_dot2c_f32_bf16_dpp v54, v34, v107 quad_perm:[1,1,1,1] row_mask:0xf bank_mask:0xf
    v_dot2c_f32_bf16_dpp v55, v42, v107 quad_perm:[1,1,1,1] row_mask:0xf bank_mask:0xf
    v_dot2c_f32_bf16_dpp v48, v35, v108 quad_perm:[1,1,1,1] row_mask:0xf bank_mask:0xf
    v_dot2c_f32_bf16_dpp v49, v43, v108 quad_perm:[1,1,1,1] row_mask:0xf bank_mask:0xf
    v_dot2c_f32_bf16_dpp v50, v35, v109 quad_perm:[1,1,1,1] row_mask:0xf bank_mask:0xf
    v_dot2c_f32_bf16_dpp v51, v43, v109 quad_perm:[1,1,1,1] row_mask:0xf bank_mask:0xf
    v_dot2c_f32_bf16_dpp v52, v35, v110 quad_perm:[1,1,1,1] row_mask:0xf bank_mask:0xf
    v_dot2c_f32_bf16_dpp v53, v43, v110 quad_perm:[1,1,1,1] row_mask:0xf bank_mask:0xf
    v_dot2c_f32_bf16_dpp v54, v35, v111 quad_perm:[1,1,1,1] row_mask:0xf bank_mask:0xf
    v_dot2c_f32_bf16_dpp v55, v43, v111 quad_perm:[1,1,1,1] row_mask:0xf bank_mask:0xf
    v_dot2c_f32_bf16_dpp v48, v36, v112 quad_perm:[1,1,1,1] row_mask:0xf bank_mask:0xf
    v_dot2c_f32_bf16_dpp v49, v44, v112 quad_perm:[1,1,1,1] row_mask:0xf bank_mask:0xf
    v_dot2c_f32_bf16_dpp v50, v36, v113 quad_perm:[1,1,1,1] row_mask:0xf bank_mask:0xf
    v_dot2c_f32_bf16_dpp v51, v44, v113 quad_perm:[1,1,1,1] row_mask:0xf bank_mask:0xf
    v_dot2c_f32_bf16_dpp v52, v36, v114 quad_perm:[1,1,1,1] row_mask:0xf bank_mask:0xf
    v_dot2c_f32_bf16_dpp v53, v44, v114 quad_perm:[1,1,1,1] row_mask:0xf bank_mask:0xf
    v_dot2c_f32_bf16_dpp v54, v36, v115 quad_perm:[1,1,1,1] row_mask:0xf bank_mask:0xf
    v_dot2c_f32_bf16_dpp v55, v44, v115 quad_perm:[1,1,1,1] row_mask:0xf bank_mask:0xf
    v_dot2c_f32_bf16_dpp v48, v37, v116 quad_perm:[1,1,1,1] row_mask:0xf bank_mask:0xf
    v_dot2c_f32_bf16_dpp v49, v45, v116 quad_perm:[1,1,1,1] row_mask:0xf bank_mask:0xf
    v_dot2c_f32_bf16_dpp v50, v37, v117 quad_perm:[1,1,1,1] row_mask:0xf bank_mask:0xf
    v_dot2c_f32_bf16_dpp v51, v45, v117 quad_perm:[1,1,1,1] row_mask:0xf bank_mask:0xf
    v_dot2c_f32_bf16_dpp v52, v37, v118 quad_perm:[1,1,1,1] row_mask:0xf bank_mask:0xf
    v_dot2c_f32_bf16_dpp v53, v45, v118 quad_perm:[1,1,1,1] row_mask:0xf bank_mask:0xf
    v_dot2c_f32_bf16_dpp v54, v37, v119 quad_perm:[1,1,1,1] row_mask:0xf bank_mask:0xf
    v_dot2c_f32_bf16_dpp v55, v45, v119 quad_perm:[1,1,1,1] row_mask:0xf bank_mask:0xf
    v_dot2c_f32_bf16_dpp v48, v38, v120 quad_perm:[1,1,1,1] row_mask:0xf bank_mask:0xf
    v_dot2c_f32_bf16_dpp v49, v46, v120 quad_perm:[1,1,1,1] row_mask:0xf bank_mask:0xf
    v_dot2c_f32_bf16_dpp v50, v38, v121 quad_perm:[1,1,1,1] row_mask:0xf bank_mask:0xf
    v_dot2c_f32_bf16_dpp v51, v46, v121 quad_perm:[1,1,1,1] row_mask:0xf bank_mask:0xf
    v_dot2c_f32_bf16_dpp v52, v38, v122 quad_perm:[1,1,1,1] row_mask:0xf bank_mask:0xf
    v_dot2c_f32_bf16_dpp v53, v46, v122 quad_perm:[1,1,1,1] row_mask:0xf bank_mask:0xf
    v_dot2c_f32_bf16_dpp v54, v38, v123 quad_perm:[1,1,1,1] row_mask:0xf bank_mask:0xf
    v_dot2c_f32_bf16_dpp v55, v46, v123 quad_perm:[1,1,1,1] row_mask:0xf bank_mask:0xf
    v_dot2c_f32_bf16_dpp v48, v39, v124 quad_perm:[1,1,1,1] row_mask:0xf bank_mask:0xf
    v_dot2c_f32_bf16_dpp v49, v47, v124 quad_perm:[1,1,1,1] row_mask:0xf bank_mask:0xf
    v_dot2c_f32_bf16_dpp v50, v39, v125 quad_perm:[1,1,1,1] row_mask:0xf bank_mask:0xf
    v_dot2c_f32_bf16_dpp v51, v47, v125 quad_perm:[1,1,1,1] row_mask:0xf bank_mask:0xf
    v_dot2c_f32_bf16_dpp v52, v39, v126 quad_perm:[1,1,1,1] row_mask:0xf bank_mask:0xf
    v_dot2c_f32_bf16_dpp v53, v47, v126 quad_perm:[1,1,1,1] row_mask:0xf bank_mask:0xf
    v_dot2c_f32_bf16_dpp v54, v39, v127 quad_perm:[1,1,1,1] row_mask:0xf bank_mask:0xf
    v_dot2c_f32_bf16_dpp v55, v47, v127 quad_perm:[1,1,1,1] row_mask:0xf bank_mask:0xf
    v_dot2c_f32_bf16_dpp v48, v32, v128 quad_perm:[2,2,2,2] row_mask:0xf bank_mask:0xf
    v_dot2c_f32_bf16_dpp v49, v40, v128 quad_perm:[2,2,2,2] row_mask:0xf bank_mask:0xf
    v_dot2c_f32_bf16_dpp v50, v32, v129 quad_perm:[2,2,2,2] row_mask:0xf bank_mask:0xf
    v_dot2c_f32_bf16_dpp v51, v40, v129 quad_perm:[2,2,2,2] row_mask:0xf bank_mask:0xf
    v_dot2c_f32_bf16_dpp v52, v32, v130 quad_perm:[2,2,2,2] row_mask:0xf bank_mask:0xf
    v_dot2c_f32_bf16_dpp v53, v40, v130 quad_perm:[2,2,2,2] row_mask:0xf bank_mask:0xf
    v_dot2c_f32_bf16_dpp v54, v32, v131 quad_perm:[2,2,2,2] row_mask:0xf bank_mask:0xf
    v_dot2c_f32_bf16_dpp v55, v40, v131 quad_perm:[2,2,2,2] row_mask:0xf bank_mask:0xf
    v_dot2c_f32_bf16_dpp v48, v33, v132 quad_perm:[2,2,2,2] row_mask:0xf bank_mask:0xf
    v_dot2c_f32_bf16_dpp v49, v41, v132 quad_perm:[2,2,2,2] row_mask:0xf bank_mask:0xf
    v_dot2c_f32_bf16_dpp v50, v33, v133 quad_perm:[2,2,2,2] row_mask:0xf bank_mask:0xf
    v_dot2c_f32_bf16_dpp v51, v41, v133 quad_perm:[2,2,2,2] row_mask:0xf bank_mask:0xf
    v_dot2c_f32_bf16_dpp v52, v33, v134 quad_perm:[2,2,2,2] row_mask:0xf bank_mask:0xf
    v_dot2c_f32_bf16_dpp v53, v41, v134 quad_perm:[2,2,2,2] row_mask:0xf bank_mask:0xf
    v_dot2c_f32_bf16_dpp v54, v33, v135 quad_perm:[2,2,2,2] row_mask:0xf bank_mask:0xf
    v_dot2c_f32_bf16_dpp v55, v41, v135 quad_perm:[2,2,2,2] row_mask:0xf bank_mask:0xf
    v_dot2c_f32_bf16_dpp v48, v34, v136 quad_perm:[2,2,2,2] row_mask:0xf bank_mask:0xf
    v_dot2c_f32_bf16_dpp v49, v42, v136 quad_perm:[2,2,2,2] row_mask:0xf bank_mask:0xf
    v_dot2c_f32_bf16_dpp v50, v34, v137 quad_perm:[2,2,2,2] row_mask:0xf bank_mask:0xf
    v_dot2c_f32_bf16_dpp v51, v42, v137 quad_perm:[2,2,2,2] row_mask:0xf bank_mask:0xf
    v_dot2c_f32_bf16_dpp v52, v34, v138 quad_perm:[2,2,2,2] row_mask:0xf bank_mask:0xf
    v_dot2c_f32_bf16_dpp v53, v42, v138 quad_perm:[2,2,2,2] row_mask:0xf bank_mask:0xf
    v_dot2c_f32_bf16_dpp v54, v34, v139 quad_perm:[2,2,2,2] row_mask:0xf bank_mask:0xf
    v_dot2c_f32_bf16_dpp v55, v42, v139 quad_perm:[2,2,2,2] row_mask:0xf bank_mask:0xf
    v_dot2c_f32_bf16_dpp v48, v35, v140 quad_perm:[2,2,2,2] row_mask:0xf bank_mask:0xf
    v_dot2c_f32_bf16_dpp v49, v43, v140 quad_perm:[2,2,2,2] row_mask:0xf bank_mask:0xf
    v_dot2c_f32_bf16_dpp v50, v35, v141 quad_perm:[2,2,2,2] row_mask:0xf bank_mask:0xf
    v_dot2c_f32_bf16_dpp v51, v43, v141 quad_perm:[2,2,2,2] row_mask:0xf bank_mask:0xf
    v_dot2c_f32_bf16_dpp v52, v35, v142 quad_perm:[2,2,2,2] row_mask:0xf bank_mask:0xf
    v_dot2c_f32_bf16_dpp v53, v43, v142 quad_perm:[2,2,2,2] row_mask:0xf bank_mask:0xf
    v_dot2c_f32_bf16_dpp v54, v35, v143 quad_perm:[2,2,2,2] row_mask:0xf bank_mask:0xf
    v_dot2c_f32_bf16_dpp v55, v43, v143 quad_perm:[2,2,2,2] row_mask:0xf bank_mask:0xf
    v_dot2c_f32_bf16_dpp v48, v36, v144 quad_perm:[2,2,2,2] row_mask:0xf bank_mask:0xf
    v_dot2c_f32_bf16_dpp v49, v44, v144 quad_perm:[2,2,2,2] row_mask:0xf bank_mask:0xf
    v_dot2c_f32_bf16_dpp v50, v36, v145 quad_perm:[2,2,2,2] row_mask:0xf bank_mask:0xf
    v_dot2c_f32_bf16_dpp v51, v44, v145 quad_perm:[2,2,2,2] row_mask:0xf bank_mask:0xf
    v_dot2c_f32_bf16_dpp v52, v36, v146 quad_perm:[2,2,2,2] row_mask:0xf bank_mask:0xf
    v_dot2c_f32_bf16_dpp v53, v44, v146 quad_perm:[2,2,2,2] row_mask:0xf bank_mask:0xf
    v_dot2c_f32_bf16_dpp v54, v36, v147 quad_perm:[2,2,2,2] row_mask:0xf bank_mask:0xf
    v_dot2c_f32_bf16_dpp v55, v44, v147 quad_perm:[2,2,2,2] row_mask:0xf bank_mask:0xf
    v_dot2c_f32_bf16_dpp v48, v37, v148 quad_perm:[2,2,2,2] row_mask:0xf bank_mask:0xf
    v_dot2c_f32_bf16_dpp v49, v45, v148 quad_perm:[2,2,2,2] row_mask:0xf bank_mask:0xf
    v_dot2c_f32_bf16_dpp v50, v37, v149 quad_perm:[2,2,2,2] row_mask:0xf bank_mask:0xf
    v_dot2c_f32_bf16_dpp v51, v45, v149 quad_perm:[2,2,2,2] row_mask:0xf bank_mask:0xf
    v_dot2c_f32_bf16_dpp v52, v37, v150 quad_perm:[2,2,2,2] row_mask:0xf bank_mask:0xf
    v_dot2c_f32_bf16_dpp v53, v45, v150 quad_perm:[2,2,2,2] row_mask:0xf bank_mask:0xf
    v_dot2c_f32_bf16_dpp v54, v37, v151 quad_perm:[2,2,2,2] row_mask:0xf bank_mask:0xf
    v_dot2c_f32_bf16_dpp v55, v45, v151 quad_perm:[2,2,2,2] row_mask:0xf bank_mask:0xf
    v_dot2c_f32_bf16_dpp v48, v38, v152 quad_perm:[2,2,2,2] row_mask:0xf bank_mask:0xf
    v_dot2c_f32_bf16_dpp v49, v46, v152 quad_perm:[2,2,2,2] row_mask:0xf bank_mask:0xf
    v_dot2c_f32_bf16_dpp v50, v38, v153 quad_perm:[2,2,2,2] row_mask:0xf bank_mask:0xf
    v_dot2c_f32_bf16_dpp v51, v46, v153 quad_perm:[2,2,2,2] row_mask:0xf bank_mask:0xf
    v_dot2c_f32_bf16_dpp v52, v38, v154 quad_perm:[2,2,2,2] row_mask:0xf bank_mask:0xf
    v_dot2c_f32_bf16_dpp v53, v46, v154 quad_perm:[2,2,2,2] row_mask:0xf bank_mask:0xf
    v_dot2c_f32_bf16_dpp v54, v38, v155 quad_perm:[2,2,2,2] row_mask:0xf bank_mask:0xf
    v_dot2c_f32_bf16_dpp v55, v46, v155 quad_perm:[2,2,2,2] row_mask:0xf bank_mask:0xf
    v_dot2c_f32_bf16_dpp v48, v39, v156 quad_perm:[2,2,2,2] row_mask:0xf bank_mask:0xf
    v_dot2c_f32_bf16_dpp v49, v47, v156 quad_perm:[2,2,2,2] row_mask:0xf bank_mask:0xf
    v_dot2c_f32_bf16_dpp v50, v39, v157 quad_perm:[2,2,2,2] row_mask:0xf bank_mask:0xf
    v_dot2c_f32_bf16_dpp v51, v47, v157 quad_perm:[2,2,2,2] row_mask:0xf bank_mask:0xf
    v_dot2c_f32_bf16_dpp v52, v39, v158 quad_perm:[2,2,2,2] row_mask:0xf bank_mask:0xf
    v_dot2c_f32_bf16_dpp v53, v47, v158 quad_perm:[2,2,2,2] row_mask:0xf bank_mask:0xf
    v_dot2c_f32_bf16_dpp v54, v39, v159 quad_perm:[2,2,2,2] row_mask:0xf bank_mask:0xf
    v_dot2c_f32_bf16_dpp v55, v47, v159 quad_perm:[2,2,2,2] row_mask:0xf bank_mask:0xf
    v_dot2c_f32_bf16_dpp v48, v32, v160 quad_perm:[3,3,3,3] row_mask:0xf bank_mask:0xf
    v_dot2c_f32_bf16_dpp v49, v40, v160 quad_perm:[3,3,3,3] row_mask:0xf bank_mask:0xf
    v_dot2c_f32_bf16_dpp v50, v32, v161 quad_perm:[3,3,3,3] row_mask:0xf bank_mask:0xf
    v_dot2c_f32_bf16_dpp v51, v40, v161 quad_perm:[3,3,3,3] row_mask:0xf bank_mask:0xf
    v_dot2c_f32_bf16_dpp v52, v32, v162 quad_perm:[3,3,3,3] row_mask:0xf bank_mask:0xf
    v_dot2c_f32_bf16_dpp v53, v40, v162 quad_perm:[3,3,3,3] row_mask:0xf bank_mask:0xf
    v_dot2c_f32_bf16_dpp v54, v32, v163 quad_perm:[3,3,3,3] row_mask:0xf bank_mask:0xf
    v_dot2c_f32_bf16_dpp v55, v40, v163 quad_perm:[3,3,3,3] row_mask:0xf bank_mask:0xf
    v_dot2c_f32_bf16_dpp v48, v33, v164 quad_perm:[3,3,3,3] row_mask:0xf bank_mask:0xf
    v_dot2c_f32_bf16_dpp v49, v41, v164 quad_perm:[3,3,3,3] row_mask:0xf bank_mask:0xf
    v_dot2c_f32_bf16_dpp v50, v33, v165 quad_perm:[3,3,3,3] row_mask:0xf bank_mask:0xf
    v_dot2c_f32_bf16_dpp v51, v41, v165 quad_perm:[3,3,3,3] row_mask:0xf bank_mask:0xf
    v_dot2c_f32_bf16_dpp v52, v33, v166 quad_perm:[3,3,3,3] row_mask:0xf bank_mask:0xf
    v_dot2c_f32_bf16_dpp v53, v41, v166 quad_perm:[3,3,3,3] row_mask:0xf bank_mask:0xf
    v_dot2c_f32_bf16_dpp v54, v33, v167 quad_perm:[3,3,3,3] row_mask:0xf bank_mask:0xf
    v_dot2c_f32_bf16_dpp v55, v41, v167 quad_perm:[3,3,3,3] row_mask:0xf bank_mask:0xf
    v_dot2c_f32_bf16_dpp v48, v34, v168 quad_perm:[3,3,3,3] row_mask:0xf bank_mask:0xf
    v_dot2c_f32_bf16_dpp v49, v42, v168 quad_perm:[3,3,3,3] row_mask:0xf bank_mask:0xf
    v_dot2c_f32_bf16_dpp v50, v34, v169 quad_perm:[3,3,3,3] row_mask:0xf bank_mask:0xf
    v_dot2c_f32_bf16_dpp v51, v42, v169 quad_perm:[3,3,3,3] row_mask:0xf bank_mask:0xf
    v_dot2c_f32_bf16_dpp v52, v34, v170 quad_perm:[3,3,3,3] row_mask:0xf bank_mask:0xf
    v_dot2c_f32_bf16_dpp v53, v42, v170 quad_perm:[3,3,3,3] row_mask:0xf bank_mask:0xf
    v_dot2c_f32_bf16_dpp v54, v34, v171 quad_perm:[3,3,3,3] row_mask:0xf bank_mask:0xf
    v_dot2c_f32_bf16_dpp v55, v42, v171 quad_perm:[3,3,3,3] row_mask:0xf bank_mask:0xf
    v_dot2c_f32_bf16_dpp v48, v35, v172 quad_perm:[3,3,3,3] row_mask:0xf bank_mask:0xf
    v_dot2c_f32_bf16_dpp v49, v43, v172 quad_perm:[3,3,3,3] row_mask:0xf bank_mask:0xf
    v_dot2c_f32_bf16_dpp v50, v35, v173 quad_perm:[3,3,3,3] row_mask:0xf bank_mask:0xf
    v_dot2c_f32_bf16_dpp v51, v43, v173 quad_perm:[3,3,3,3] row_mask:0xf bank_mask:0xf
    v_dot2c_f32_bf16_dpp v52, v35, v174 quad_perm:[3,3,3,3] row_mask:0xf bank_mask:0xf
    v_dot2c_f32_bf16_dpp v53, v43, v174 quad_perm:[3,3,3,3] row_mask:0xf bank_mask:0xf
    v_dot2c_f32_bf16_dpp v54, v35, v175 quad_perm:[3,3,3,3] row_mask:0xf bank_mask:0xf
    v_dot2c_f32_bf16_dpp v55, v43, v175 quad_perm:[3,3,3,3] row_mask:0xf bank_mask:0xf
    v_dot2c_f32_bf16_dpp v48, v36, v176 quad_perm:[3,3,3,3] row_mask:0xf bank_mask:0xf
    v_dot2c_f32_bf16_dpp v49, v44, v176 quad_perm:[3,3,3,3] row_mask:0xf bank_mask:0xf
    v_dot2c_f32_bf16_dpp v50, v36, v177 quad_perm:[3,3,3,3] row_mask:0xf bank_mask:0xf
    v_dot2c_f32_bf16_dpp v51, v44, v177 quad_perm:[3,3,3,3] row_mask:0xf bank_mask:0xf
    v_dot2c_f32_bf16_dpp v52, v36, v178 quad_perm:[3,3,3,3] row_mask:0xf bank_mask:0xf
    v_dot2c_f32_bf16_dpp v53, v44, v178 quad_perm:[3,3,3,3] row_mask:0xf bank_mask:0xf
    v_dot2c_f32_bf16_dpp v54, v36, v179 quad_perm:[3,3,3,3] row_mask:0xf bank_mask:0xf
    v_dot2c_f32_bf16_dpp v55, v44, v179 quad_perm:[3,3,3,3] row_mask:0xf bank_mask:0xf
    v_dot2c_f32_bf16_dpp v48, v37, v180 quad_perm:[3,3,3,3] row_mask:0xf bank_mask:0xf
    v_dot2c_f32_bf16_dpp v49, v45, v180 quad_perm:[3,3,3,3] row_mask:0xf bank_mask:0xf
    v_dot2c_f32_bf16_dpp v50, v37, v181 quad_perm:[3,3,3,3] row_mask:0xf bank_mask:0xf
    v_dot2c_f32_bf16_dpp v51, v45, v181 quad_perm:[3,3,3,3] row_mask:0xf bank_mask:0xf
    v_dot2c_f32_bf16_dpp v52, v37, v182 quad_perm:[3,3,3,3] row_mask:0xf bank_mask:0xf
    v_dot2c_f32_bf16_dpp v53, v45, v182 quad_perm:[3,3,3,3] row_mask:0xf bank_mask:0xf
    v_dot2c_f32_bf16_dpp v54, v37, v183 quad_perm:[3,3,3,3] row_mask:0xf bank_mask:0xf
    v_dot2c_f32_bf16_dpp v55, v45, v183 quad_perm:[3,3,3,3] row_mask:0xf bank_mask:0xf
    v_dot2c_f32_bf16_dpp v48, v38, v184 quad_perm:[3,3,3,3] row_mask:0xf bank_mask:0xf
    v_dot2c_f32_bf16_dpp v49, v46, v184 quad_perm:[3,3,3,3] row_mask:0xf bank_mask:0xf
    v_dot2c_f32_bf16_dpp v50, v38, v185 quad_perm:[3,3,3,3] row_mask:0xf bank_mask:0xf
    v_dot2c_f32_bf16_dpp v51, v46, v185 quad_perm:[3,3,3,3] row_mask:0xf bank_mask:0xf
    v_dot2c_f32_bf16_dpp v52, v38, v186 quad_perm:[3,3,3,3] row_mask:0xf bank_mask:0xf
    v_dot2c_f32_bf16_dpp v53, v46, v186 quad_perm:[3,3,3,3] row_mask:0xf bank_mask:0xf
    v_dot2c_f32_bf16_dpp v54, v38, v187 quad_perm:[3,3,3,3] row_mask:0xf bank_mask:0xf
    v_dot2c_f32_bf16_dpp v55, v46, v187 quad_perm:[3,3,3,3] row_mask:0xf bank_mask:0xf
    v_dot2c_f32_bf16_dpp v48, v39, v188 quad_perm:[3,3,3,3] row_mask:0xf bank_mask:0xf
    v_dot2c_f32_bf16_dpp v49, v47, v188 quad_perm:[3,3,3,3] row_mask:0xf bank_mask:0xf
    v_dot2c_f32_bf16_dpp v50, v39, v189 quad_perm:[3,3,3,3] row_mask:0xf bank_mask:0xf
    v_dot2c_f32_bf16_dpp v51, v47, v189 quad_perm:[3,3,3,3] row_mask:0xf bank_mask:0xf
    v_dot2c_f32_bf16_dpp v52, v39, v190 quad_perm:[3,3,3,3] row_mask:0xf bank_mask:0xf
    v_dot2c_f32_bf16_dpp v53, v47, v190 quad_perm:[3,3,3,3] row_mask:0xf bank_mask:0xf
    v_dot2c_f32_bf16_dpp v54, v39, v191 quad_perm:[3,3,3,3] row_mask:0xf bank_mask:0xf
    v_dot2c_f32_bf16_dpp v55, v47, v191 quad_perm:[3,3,3,3] row_mask:0xf bank_mask:0xf
    v_add_u32 v3, 64, v3
    s_add_u32 s16, s16, 1
    s_cmp_lt_u32 s16, 2
    s_cbranch_scc1 L_mrp
    s_nop 1
    v_add_f32_dpp v48, v48, v48 row_ror:8 row_mask:0xf bank_mask:0x3
    v_add_f32_dpp v49, v49, v49 row_ror:8 row_mask:0xf bank_mask:0x3
    v_add_f32_dpp v50, v50, v50 row_ror:8 row_mask:0xf bank_mask:0x3
    v_add_f32_dpp v51, v51, v51 row_ror:8 row_mask:0xf bank_mask:0x3
    v_add_f32_dpp v48, v52, v52 row_ror:8 row_mask:0xf bank_mask:0xc
    v_add_f32_dpp v49, v53, v53 row_ror:8 row_mask:0xf bank_mask:0xc
    v_add_f32_dpp v50, v54, v54 row_ror:8 row_mask:0xf bank_mask:0xc
    v_add_f32_dpp v51, v55, v55 row_ror:8 row_mask:0xf bank_mask:0xc
    s_nop 0
    v_permlane16_swap_b32 v48, v50
    v_permlane16_swap_b32 v49, v51
    v_add_f32 v48, v48, v50
    v_add_f32 v49, v49, v51
    v_mov_b32 v50, v48
    v_mov_b32 v51, v49
    s_nop 0
    v_permlane32_swap_b32 v48, v50
    v_permlane32_swap_b32 v49, v51
    v_add_f32 v48, v48, v50
    v_add_f32 v49, v49, v51
    v_cvt_pk_bf16_f32 v50, v48, v49
    v_mov_b32 v51, s22
    v_bfe_u32 v7, v1, 3, 1
    v_lshl_add_u32 v7, v6, 1, v7
    v_bfe_u32 v5, v1, 4, 1
    v_lshl_add_u32 v7, v7, 1, v5
    s_lshl_b32 s29, s37, 8
    s_add_u32 s29, s29, 8192
    v_lshl_add_u32 v5, v7, 3, s29
    s_mov_b32 exec_hi, 0
    global_store_dwordx2 v5, v[50:51], s[66:67] sc1
    s_endpgm
L_crole:
    s_lshl_b32 s16, s5, 2
    s_add_u32 s16, s16, s7
    v_and_b32 v5, 15, v1
    v_lshrrev_b32 v6, 4, v1
    v_lshlrev_b32 v4, 11, v6
    v_lshl_add_u32 v4, v5, 3, v4
    s_lshl_b32 s29, s16, 17
    s_lshl_b32 s30, s37, 7
    s_add_u32 s29, s29, s30
    v_add_u32 v4, s29, v4
    s_waitcnt vmcnt(0)
    global_load_dwordx2 v[120:121], v4, s[48:49] nt
    global_load_dwordx2 v[122:123], v4, s[48:49] offset:1024 nt
    v_add_u32 v4, 8192, v4
    global_load_dwordx2 v[124:125], v4, s[48:49] nt
    global_load_dwordx2 v[126:127], v4, s[48:49] offset:1024 nt
    v_add_u32 v4, 8192, v4
    s_waitcnt vmcnt(0)
    global_load_dwordx2 v[128:129], v4, s[48:49] nt
    global_load_dwordx2 v[130:131], v4, s[48:49] offset:1024 nt
    v_add_u32 v4, 8192, v4
    global_load_dwordx2 v[132:133], v4, s[48:49] nt
    global_load_dwordx2 v[134:135], v4, s[48:49] offset:1024 nt
    v_add_u32 v4, 8192, v4
    s_waitcnt vmcnt(0)
    global_load_dwordx2 v[136:137], v4, s[48:49] nt
    global_load_dwordx2 v[138:139], v4, s[48:49] offset:1024 nt
    v_add_u32 v4, 8192, v4
    global_load_dwordx2 v[140:141], v4, s[48:49] nt
    global_load_dwordx2 v[142:143], v4, s[48:49] offset:1024 nt
    v_add_u32 v4, 8192, v4
    s_waitcnt vmcnt(0)
    global_load_dwordx2 v[144:145], v4, s[48:49] nt
    global_load_dwordx2 v[146:147], v4, s[48:49] offset:1024 nt
    v_add_u32 v4, 8192, v4
    global_load_dwordx2 v[148:149], v4, s[48:49] nt
    global_load_dwordx2 v[150:151], v4, s[48:49] offset:1024 nt
    v_add_u32 v4, 8192, v4
    s_waitcnt vmcnt(0)
    global_load_dwordx2 v[152:153], v4, s[48:49] nt
    global_load_dwordx2 v[154:155], v4, s[48:49] offset:1024 nt
    v_add_u32 v4, 8192, v4
    global_load_dwordx2 v[156:157], v4, s[48:49] nt
    global_load_dwordx2 v[158:159], v4, s[48:49] offset:1024 nt
    v_add_u32 v4, 8192, v4
    s_waitcnt vmcnt(0)
    global_load_dwordx2 v[160:161], v4, s[48:49] nt
    global_load_dwordx2 v[162:163], v4, s[48:49] offset:1024 nt
    v_add_u32 v4, 8192, v4
    global_load_dwordx2 v[164:165], v4, s[48:49] nt
    global_load_dwordx2 v[166:167], v4, s[48:49] offset:1024 nt
    v_add_u32 v4, 8192, v4
    s_waitcnt vmcnt(0)
    global_load_dwordx2 v[168:169], v4, s[48:49] nt
    global_load_dwordx2 v[170:171], v4, s[48:49] offset:1024 nt
    v_add_u32 v4, 8192, v4
    global_load_dwordx2 v[172:173], v4, s[48:49] nt
    global_load_dwordx2 v[174:175], v4, s[48:49] offset:1024 nt
    v_add_u32 v4, 8192, v4
    s_waitcnt vmcnt(0)
    global_load_dwordx2 v[176:177], v4, s[48:49] nt
    global_load_dwordx2 v[178:179], v4, s[48:49] offset:1024 nt
    v_add_u32 v4, 8192, v4
    global_load_dwordx2 v[180:181], v4, s[48:49] nt
    global_load_dwordx2 v[182:183], v4, s[48:49] offset:1024 nt
    s_lshl_b32 s29, s16, 13
    s_add_u32 s29, s29, 65536
    v_lshl_add_u32 v8, v6, 11, s29
    v_lshl_add_u32 v3, v5, 4, v8
    v_lshl_add_u32 v9, v5, 2, v6
    s_lshl_b32 s29, s7, 2
    v_lshl_add_u32 v9, v9, 4, s29
    v_lshlrev_b32 v10, 4, v1
    s_lshl_b32 s29, s5, 11
    s_lshl_b32 s30, s37, 8
    s_add_u32 s29, s29, s30
    s_lshl_b32 s30, s7, 14
    s_add_u32 s29, s29, s30
    s_add_u32 s29, s29, 393216
    v_lshl_add_u32 v11, v1, 2, s29
    v_add_u32 v54, 65536, v11
    v_mov_b32 v12, 0
    v_mov_b32 v13, 0
    v_mov_b32 v14, 0
    v_mov_b32 v15, 0
    s_lshl_b32 s29, s16, 13
    s_add_u32 s29, s29, 1048580
    v_and_b32 v30, 7, v1
    v_lshl_add_u32 v30, v30, 10, s29
    s_mov_b32 s36, 0x40000
    s_nop 1
L_poll_11:
    global_load_dword v31, v30, s[66:67] sc1
    s_waitcnt vmcnt(0)
    v_cmp_ne_u32 vcc, s22, v31
    s_cbranch_vccz L_pdone_12
    s_sleep 32
    s_sub_u32 s36, s36, 1
    s_cbranch_scc0 L_poll_11
L_pdone_12:
    v_perm_b32 v20, v122, v120, s24
    v_perm_b32 v122, v122, v120, s25
    v_mov_b32 v120, v20
    v_perm_b32 v20, v123, v121, s24
    v_perm_b32 v123, v123, v121, s25
    v_mov_b32 v121, v20
    v_perm_b32 v20, v126, v124, s24
    v_perm_b32 v126, v126, v124, s25
    v_mov_b32 v124, v20
    v_perm_b32 v20, v127, v125, s24
    v_perm_b32 v127, v127, v125, s25
    v_mov_b32 v125, v20
    v_perm_b32 v20, v130, v128, s24
    v_perm_b32 v130, v130, v128, s25
    v_mov_b32 v128, v20
    v_perm_b32 v20, v131, v129, s24
    v_perm_b32 v131, v131, v129, s25
    v_mov_b32 v129, v20
    v_perm_b32 v20, v134, v132, s24
    v_perm_b32 v134, v134, v132, s25
    v_mov_b32 v132, v20
    v_perm_b32 v20, v135, v133, s24
    v_perm_b32 v135, v135, v133, s25
    v_mov_b32 v133, v20
    v_perm_b32 v20, v138, v136, s24
    v_perm_b32 v138, v138, v136, s25
    v_mov_b32 v136, v20
    v_perm_b32 v20, v139, v137, s24
    v_perm_b32 v139, v139, v137, s25
    v_mov_b32 v137, v20
    v_perm_b32 v20, v142, v140, s24
    v_perm_b32 v142, v142, v140, s25
    v_mov_b32 v140, v20
    v_perm_b32 v20, v143, v141, s24
    v_perm_b32 v143, v143, v141, s25
    v_mov_b32 v141, v20
    v_perm_b32 v20, v146, v144, s24
    v_perm_b32 v146, v146, v144, s25
    v_mov_b32 v144, v20
    v_perm_b32 v20, v147, v145, s24
    v_perm_b32 v147, v147, v145, s25
    v_mov_b32 v145, v20
    v_perm_b32 v20, v150, v148, s24
    v_perm_b32 v150, v150, v148, s25
    v_mov_b32 v148, v20
    v_perm_b32 v20, v151, v149, s24
    v_perm_b32 v151, v151, v149, s25
    v_mov_b32 v149, v20
    v_perm_b32 v20, v154, v152, s24
    v_perm_b32 v154, v154, v152, s25
    v_mov_b32 v152, v20
    v_perm_b32 v20, v155, v153, s24
    v_perm_b32 v155, v155, v153, s25
    v_mov_b32 v153, v20
    v_perm_b32 v20, v158, v156, s24
    v_perm_b32 v158, v158, v156, s25
    v_mov_b32 v156, v20
    v_perm_b32 v20, v159, v157, s24
    v_perm_b32 v159, v159, v157, s25
    v_mov_b32 v157, v20
    v_perm_b32 v20, v162, v160, s24
    v_perm_b32 v162, v162, v160, s25
    v_mov_b32 v160, v20
    v_perm_b32 v20, v163, v161, s24
    v_perm_b32 v163, v163, v161, s25
    v_mov_b32 v161, v20
    v_perm_b32 v20, v166, v164, s24
    v_perm_b32 v166, v166, v164, s25
    v_mov_b32 v164, v20
    v_perm_b32 v20, v167, v165, s24
    v_perm_b32 v167, v167, v165, s25
    v_mov_b32 v165, v20
    v_perm_b32 v20, v170, v168, s24
    v_perm_b32 v170, v170, v168, s25
    v_mov_b32 v168, v20
    v_perm_b32 v20, v171, v169, s24
    v_perm_b32 v171, v171, v169, s25
    v_mov_b32 v169, v20
    v_perm_b32 v20, v174, v172, s24
    v_perm_b32 v174, v174, v172, s25
    v_mov_b32 v172, v20
    v_perm_b32 v20, v175, v173, s24
    v_perm_b32 v175, v175, v173, s25
    v_mov_b32 v173, v20
    v_perm_b32 v20, v178, v176, s24
    v_perm_b32 v178, v178, v176, s25
    v_mov_b32 v176, v20
    v_perm_b32 v20, v179, v177, s24
    v_perm_b32 v179, v179, v177, s25
    v_mov_b32 v177, v20
    v_perm_b32 v20, v182, v180, s24
    v_perm_b32 v182, v182, v180, s25
    v_mov_b32 v180, v20
    v_perm_b32 v20, v183, v181, s24
    v_perm_b32 v183, v183, v181, s25
    v_mov_b32 v181, v20
    s_mov_b32 s38, 0x10001
    s_mov_b32 s39, 0x10001
    s_branch L_ready
L_frole:
    s_lshl_b32 s29, s37, 15
    s_lshl_b32 s30, s7, 8
    s_add_u32 s29, s29, s30
    v_lshl_add_u32 v4, v1, 2, s29
    s_waitcnt vmcnt(0)
    global_load_dword v128, v4, s[56:57] offset:0 nt
    global_load_dword v129, v4, s[56:57] offset:1024 nt
    global_load_dword v130, v4, s[56:57] offset:2048 nt
    global_load_dword v131, v4, s[56:57] offset:3072 nt
    v_add_u32 v4, 4096, v4
    s_waitcnt vmcnt(0)
    global_load_dword v132, v4, s[56:57] offset:0 nt
    global_load_dword v133, v4, s[56:57] offset:1024 nt
    global_load_dword v134, v4, s[56:57] offset:2048 nt
    global_load_dword v135, v4, s[56:57] offset:3072 nt
    v_add_u32 v4, 4096, v4
    s_waitcnt vmcnt(0)
    global_load_dword v136, v4, s[56:57] offset:0 nt
    global_load_dword v137, v4, s[56:57] offset:1024 nt
    global_load_dword v138, v4, s[56:57] offset:2048 nt
    global_load_dword v139, v4, s[56:57] offset:3072 nt
    v_add_u32 v4, 4096, v4
    s_waitcnt vmcnt(0)
    global_load_dword v140, v4, s[56:57] offset:0 nt
    global_load_dword v141, v4, s[56:57] offset:1024 nt
    global_load_dword v142, v4, s[56:57] offset:2048 nt
    global_load_dword v143, v4, s[56:57] offset:3072 nt
    v_add_u32 v4, 4096, v4
    s_waitcnt vmcnt(0)
    global_load_dword v144, v4, s[56:57] offset:0 nt
    global_load_dword v145, v4, s[56:57] offset:1024 nt
    global_load_dword v146, v4, s[56:57] offset:2048 nt
    global_load_dword v147, v4, s[56:57] offset:3072 nt
    v_add_u32 v4, 4096, v4
    s_waitcnt vmcnt(0)
    global_load_dword v148, v4, s[56:57] offset:0 nt
    global_load_dword v149, v4, s[56:57] offset:1024 nt
    global_load_dword v150, v4, s[56:57] offset:2048 nt
    global_load_dword v151, v4, s[56:57] offset:3072 nt
    v_add_u32 v4, 4096, v4
    s_waitcnt vmcnt(0)
    global_load_dword v152, v4, s[56:57] offset:0 nt
    global_load_dword v153, v4, s[56:57] offset:1024 nt
    global_load_dword v154, v4, s[56:57] offset:2048 nt
    global_load_dword v155, v4, s[56:57] offset:3072 nt
    v_add_u32 v4, 4096, v4
    s_waitcnt vmcnt(0)
    global_load_dword v156, v4, s[56:57] offset:0 nt
    global_load_dword v157, v4, s[56:57] offset:1024 nt
    global_load_dword v158, v4, s[56:57] offset:2048 nt
    global_load_dword v159, v4, s[56:57] offset:3072 nt
    v_bfe_u32 v5, v1, 4, 1
    v_lshlrev_b32 v5, 6, v5
    v_bfe_u32 v6, v1, 5, 1
    v_lshl_add_u32 v5, v6, 1, v5
    s_lshl_b32 s29, s7, 7
    v_add_u32 v5, s29, v5
    v_mul_u32_u24 v6, 3584, v5
    v_and_b32 v7, 7, v1
    v_lshl_add_u32 v6, v7, 3, v6
    s_lshl_b32 s29, s37, 6
    v_add_u32 v6, s29, v6
    v_and_b32 v7, 8, v1
    v_cmp_ne_u32 vcc, 0, v7
    v_mov_b32 v8, s52
    v_mov_b32 v9, s54
    v_cndmask_b32 v8, v8, v9, vcc
    v_mov_b32 v9, s53
    v_mov_b32 v10, s55
    v_cndmask_b32 v9, v9, v10, vcc
    v_add_co_u32 v8, vcc, v8, v6
    s_nop 1
    v_addc_co_u32 v9, vcc, 0, v9, vcc
    s_waitcnt vmcnt(0)
    global_load_dwordx2 v[64:65], v[8:9], off nt
    global_load_dwordx2 v[66:67], v[8:9], off offset:3584 nt
    v_add_co_u32 v8, vcc, 14336, v8
    s_nop 1
    v_addc_co_u32 v9, vcc, 0, v9, vcc
    s_waitcnt vmcnt(0)
    global_load_dwordx2 v[68:69], v[8:9], off nt
    global_load_dwordx2 v[70:71], v[8:9], off offset:3584 nt
    v_add_co_u32 v8, vcc, 14336, v8
    s_nop 1
    v_addc_co_u32 v9, vcc, 0, v9, vcc
    s_waitcnt vmcnt(0)
    global_load_dwordx2 v[72:73], v[8:9], off nt
    global_load_dwordx2 v[74:75], v[8:9], off offset:3584 nt
    v_add_co_u32 v8, vcc, 14336, v8
    s_nop 1
    v_addc_co_u32 v9, vcc, 0, v9, vcc
    s_waitcnt vmcnt(0)
    global_load_dwordx2 v[76:77], v[8:9], off nt
    global_load_dwordx2 v[78:79], v[8:9], off offset:3584 nt
    v_add_co_u32 v8, vcc, 14336, v8
    s_nop 1
    v_addc_co_u32 v9, vcc, 0, v9, vcc
    s_waitcnt vmcnt(0)
    global_load_dwordx2 v[80:81], v[8:9], off nt
    global_load_dwordx2 v[82:83], v[8:9], off offset:3584 nt
    v_add_co_u32 v8, vcc, 14336, v8
    s_nop 1
    v_addc_co_u32 v9, vcc, 0, v9, vcc
    s_waitcnt vmcnt(0)
    global_load_dwordx2 v[84:85], v[8:9], off nt
    global_load_dwordx2 v[86:87], v[8:9], off offset:3584 nt
    v_add_co_u32 v8, vcc, 14336, v8
    s_nop 1
    v_addc_co_u32 v9, vcc, 0, v9, vcc
    s_waitcnt vmcnt(0)
    global_load_dwordx2 v[88:89], v[8:9], off nt
    global_load_dwordx2 v[90:91], v[8:9], off offset:3584 nt
    v_add_co_u32 v8, vcc, 14336, v8
    s_nop 1
    v_addc_co_u32 v9, vcc, 0, v9, vcc
    s_waitcnt vmcnt(0)
    global_load_dwordx2 v[92:93], v[8:9], off nt
    global_load_dwordx2 v[94:95], v[8:9], off offset:3584 nt
    v_add_co_u32 v8, vcc, 14336, v8
    s_nop 1
    v_addc_co_u32 v9, vcc, 0, v9, vcc
    s_waitcnt vmcnt(0)
    global_load_dwordx2 v[96:97], v[8:9], off nt
    global_load_dwordx2 v[98:99], v[8:9], off offset:3584 nt
    v_add_co_u32 v8, vcc, 14336, v8
    s_nop 1
    v_addc_co_u32 v9, vcc, 0, v9, vcc
    s_waitcnt vmcnt(0)
    global_load_dwordx2 v[100:101], v[8:9], off nt
    global_load_dwordx2 v[102:103], v[8:9], off offset:3584 nt
    v_add_co_u32 v8, vcc, 14336, v8
    s_nop 1
    v_addc_co_u32 v9, vcc, 0, v9, vcc
    s_waitcnt vmcnt(0)
    global_load_dwordx2 v[104:105], v[8:9], off nt
    global_load_dwordx2 v[106:107], v[8:9], off offset:3584 nt
    v_add_co_u32 v8, vcc, 14336, v8
    s_nop 1
    v_addc_co_u32 v9, vcc, 0, v9, vcc
    s_waitcnt vmcnt(0)
    global_load_dwordx2 v[108:109], v[8:9], off nt
    global_load_dwordx2 v[110:111], v[8:9], off offset:3584 nt
    v_add_co_u32 v8, vcc, 14336, v8
    s_nop 1
    v_addc_co_u32 v9, vcc, 0, v9, vcc
    s_waitcnt vmcnt(0)
    global_load_dwordx2 v[112:113], v[8:9], off nt
    global_load_dwordx2 v[114:115], v[8:9], off offset:3584 nt
    v_add_co_u32 v8, vcc, 14336, v8
    s_nop 1
    v_addc_co_u32 v9, vcc, 0, v9, vcc
    s_waitcnt vmcnt(0)
    global_load_dwordx2 v[116:117], v[8:9], off nt
    global_load_dwordx2 v[118:119], v[8:9], off offset:3584 nt
    v_add_co_u32 v8, vcc, 14336, v8
    s_nop 1
    v_addc_co_u32 v9, vcc, 0, v9, vcc
    s_waitcnt vmcnt(0)
    global_load_dwordx2 v[120:121], v[8:9], off nt
    global_load_dwordx2 v[122:123], v[8:9], off offset:3584 nt
    v_add_co_u32 v8, vcc, 14336, v8
    s_nop 1
    v_addc_co_u32 v9, vcc, 0, v9, vcc
    s_waitcnt vmcnt(0)
    global_load_dwordx2 v[124:125], v[8:9], off nt
    global_load_dwordx2 v[126:127], v[8:9], off offset:3584 nt
    v_and_b32 v31, 31, v1
    v_lshlrev_b32 v31, 2, v31
    v_lshrrev_b32 v5, 5, v1
    v_lshl_add_u32 v31, v5, 1, v31
    s_lshl_b32 s29, s7, 7
    v_add_u32 v31, s29, v31
    v_lshlrev_b32 v53, 1, v31
    global_load_dword v32, v53, s[40:41]
    v_lshlrev_b32 v3, 2, v31
    v_add_u32 v3, 8192, v3
    v_add_u32 v4, 4096, v3
    v_and_b32 v33, 3, v1
    v_lshlrev_b32 v33, 2, v33
    v_bfe_u32 v5, v1, 3, 1
    v_lshl_add_u32 v33, v5, 1, v33
    v_bfe_u32 v5, v1, 2, 1
    v_add_u32 v33, v33, v5
    s_and_b32 s29, s37, 31
    s_lshl_b32 s29, s29, 4
    v_add_u32 v33, s29, v33
    v_lshrrev_b32 v5, 1, v33
    v_lshlrev_b32 v5, 3, v5
    v_add_u32 v5, 14336, v5
    v_bfe_u32 v30, v1, 3, 1
    v_and_b32 v27, 3, v1
    v_lshl_add_u32 v30, v30, 2, v27
    v_and_b32 v27, 7, v1
    v_lshl_add_u32 v30, v30, 3, v27
    s_lshl_b32 s29, s7, 16
    s_add_u32 s29, s29, 1048580
    v_lshl_add_u32 v30, v30, 10, s29
    s_mov_b32 s36, 0x40000
    s_nop 1
L_poll_13:
    global_load_dword v27, v30, s[66:67] sc1
    s_waitcnt vmcnt(0)
    v_cmp_ne_u32 vcc, s22, v27
    s_cbranch_vccz L_pdone_14
    s_sleep 32
    s_sub_u32 s36, s36, 1
    s_cbranch_scc0 L_poll_13
L_pdone_14:
    s_lshr_b32 s18, s37, 3
    s_cmp_lg_u32 s18, s7
    s_cbranch_scc1 L_noqz
    v_lshrrev_b32 v27, 3, v1
    v_and_b32 v30, 3, v27
    v_xor_b32 v30, 1, v30
    v_lshl_add_u32 v27, v30, 3, v27
    v_and_b32 v30, 7, v1
    v_lshl_add_u32 v30, v30, 5, v27
    v_lshlrev_b32 v30, 10, v30
    v_add_u32 v30, 1048580, v30
    s_mov_b32 s36, 0x40000
    s_nop 1
L_poll_15:
    global_load_dword v27, v30, s[66:67] sc1
    s_waitcnt vmcnt(0)
    v_cmp_ne_u32 vcc, s22, v27
    s_cbranch_vccz L_pdone_16
    s_sleep 32
    s_sub_u32 s36, s36, 1
    s_cbranch_scc0 L_poll_15
L_pdone_16:
L_noqz:
    s_mov_b32 s36, 0x40000
    s_nop 1
L_poll_17:
    global_load_dwordx2 v[34:35], v3, s[66:67] sc1
    global_load_dwordx2 v[36:37], v3, s[66:67] offset:2048 sc1
    global_load_dwordx2 v[38:39], v4, s[66:67] sc1
    global_load_dwordx2 v[40:41], v5, s[66:67] sc1
    s_waitcnt vmcnt(0)
    v_min3_u32 v28, v35, v37, v39
    v_max3_u32 v29, v35, v37, v39
    v_min_u32 v28, v28, v41
    v_max_u32 v29, v29, v41
    v_xor_b32 v28, s22, v28
    v_xor_b32 v29, s22, v29
    v_or_b32 v28, v28, v29
    v_cmp_ne_u32 vcc, 0, v28
    s_cbranch_vccz L_pdone_18
    s_sleep 100
    s_sub_u32 s36, s36, 1
    s_cbranch_scc0 L_poll_17
L_pdone_18:
    v_perm_b32 v20, v66, v64, s24
    v_perm_b32 v66, v66, v64, s25
    v_mov_b32 v64, v20
    v_perm_b32 v20, v67, v65, s24
    v_perm_b32 v67, v67, v65, s25
    v_mov_b32 v65, v20
    v_perm_b32 v20, v129, v128, s24
    v_perm_b32 v129, v129, v128, s25
    v_mov_b32 v128, v20
    v_perm_b32 v20, v70, v68, s24
    v_perm_b32 v70, v70, v68, s25
    v_mov_b32 v68, v20
    v_perm_b32 v20, v71, v69, s24
    v_perm_b32 v71, v71, v69, s25
    v_mov_b32 v69, v20
    v_perm_b32 v20, v131, v130, s24
    v_perm_b32 v131, v131, v130, s25
    v_mov_b32 v130, v20
    v_perm_b32 v20, v74, v72, s24
    v_perm_b32 v74, v74, v72, s25
    v_mov_b32 v72, v20
    v_perm_b32 v20, v75, v73, s24
    v_perm_b32 v75, v75, v73, s25
    v_mov_b32 v73, v20
    v_perm_b32 v20, v133, v132, s24
    v_perm_b32 v133, v133, v132, s25
    v_mov_b32 v132, v20
    v_perm_b32 v20, v78, v76, s24
    v_perm_b32 v78, v78, v76, s25
    v_mov_b32 v76, v20
    v_perm_b32 v20, v79, v77, s24
    v_perm_b32 v79, v79, v77, s25
    v_mov_b32 v77, v20
    v_perm_b32 v20, v135, v134, s24
    v_perm_b32 v135, v135, v134, s25
    v_mov_b32 v134, v20
    v_perm_b32 v20, v82, v80, s24
    v_perm_b32 v82, v82, v80, s25
    v_mov_b32 v80, v20
    v_perm_b32 v20, v83, v81, s24
    v_perm_b32 v83, v83, v81, s25
    v_mov_b32 v81, v20
    v_perm_b32 v20, v137, v136, s24
    v_perm_b32 v137, v137, v136, s25
    v_mov_b32 v136, v20
    v_perm_b32 v20, v86, v84, s24
    v_perm_b32 v86, v86, v84, s25
    v_mov_b32 v84, v20
    v_perm_b32 v20, v87, v85, s24
    v_perm_b32 v87, v87, v85, s25
    v_mov_b32 v85, v20
    v_perm_b32 v20, v139, v138, s24
    v_perm_b32 v139, v139, v138, s25
    v_mov_b32 v138, v20
    v_perm_b32 v20, v90, v88, s24
    v_perm_b32 v90, v90, v88, s25
    v_mov_b32 v88, v20
    v_perm_b32 v20, v91, v89, s24
    v_perm_b32 v91, v91, v89, s25
    v_mov_b32 v89, v20
    v_perm_b32 v20, v141, v140, s24
    v_perm_b32 v141, v141, v140, s25
    v_mov_b32 v140, v20
    v_perm_b32 v20, v94, v92, s24
    v_perm_b32 v94, v94, v92, s25
    v_mov_b32 v92, v20
    v_perm_b32 v20, v95, v93, s24
    v_perm_b32 v95, v95, v93, s25
    v_mov_b32 v93, v20
    v_perm_b32 v20, v143, v142, s24
    v_perm_b32 v143, v143, v142, s25
    v_mov_b32 v142, v20
    v_perm_b32 v20, v98, v96, s24
    v_perm_b32 v98, v98, v96, s25
    v_mov_b32 v96, v20
    v_perm_b32 v20, v99, v97, s24
    v_perm_b32 v99, v99, v97, s25
    v_mov_b32 v97, v20
    v_perm_b32 v20, v145, v144, s24
    v_perm_b32 v145, v145, v144, s25
    v_mov_b32 v144, v20
    v_perm_b32 v20, v102, v100, s24
    v_perm_b32 v102, v102, v100, s25
    v_mov_b32 v100, v20
    v_perm_b32 v20, v103, v101, s24
    v_perm_b32 v103, v103, v101, s25
    v_mov_b32 v101, v20
    v_perm_b32 v20, v147, v146, s24
    v_perm_b32 v147, v147, v146, s25
    v_mov_b32 v146, v20
    v_perm_b32 v20, v106, v104, s24
    v_perm_b32 v106, v106, v104, s25
    v_mov_b32 v104, v20
    v_perm_b32 v20, v107, v105, s24
    v_perm_b32 v107, v107, v105, s25
    v_mov_b32 v105, v20
    v_perm_b32 v20, v149, v148, s24
    v_perm_b32 v149, v149, v148, s25
    v_mov_b32 v148, v20
    v_perm_b32 v20, v110, v108, s24
    v_perm_b32 v110, v110, v108, s25
    v_mov_b32 v108, v20
    v_perm_b32 v20, v111, v109, s24
    v_perm_b32 v111, v111, v109, s25
    v_mov_b32 v109, v20
    v_perm_b32 v20, v151, v150, s24
    v_perm_b32 v151, v151, v150, s25
    v_mov_b32 v150, v20
    v_perm_b32 v20, v114, v112, s24
    v_perm_b32 v114, v114, v112, s25
    v_mov_b32 v112, v20
    v_perm_b32 v20, v115, v113, s24
    v_perm_b32 v115, v115, v113, s25
    v_mov_b32 v113, v20
    v_perm_b32 v20, v153, v152, s24
    v_perm_b32 v153, v153, v152, s25
    v_mov_b32 v152, v20
    v_perm_b32 v20, v118, v116, s24
    v_perm_b32 v118, v118, v116, s25
    v_mov_b32 v116, v20
    v_perm_b32 v20, v119, v117, s24
    v_perm_b32 v119, v119, v117, s25
    v_mov_b32 v117, v20
    v_perm_b32 v20, v155, v154, s24
    v_perm_b32 v155, v155, v154, s25
    v_mov_b32 v154, v20
    v_perm_b32 v20, v122, v120, s24
    v_perm_b32 v122, v122, v120, s25
    v_mov_b32 v120, v20
    v_perm_b32 v20, v123, v121, s24
    v_perm_b32 v123, v123, v121, s25
    v_mov_b32 v121, v20
    v_perm_b32 v20, v157, v156, s24
    v_perm_b32 v157, v157, v156, s25
    v_mov_b32 v156, v20
    v_perm_b32 v20, v126, v124, s24
    v_perm_b32 v126, v126, v124, s25
    v_mov_b32 v124, v20
    v_perm_b32 v20, v127, v125, s24
    v_perm_b32 v127, v127, v125, s25
    v_mov_b32 v125, v20
    v_perm_b32 v20, v159, v158, s24
    v_perm_b32 v159, v159, v158, s25
    v_mov_b32 v158, v20
    v_and_b32 v43, 0xffff0000, v32
    v_lshlrev_b32 v42, 16, v32
    v_and_b32 v45, 0xffff0000, v34
    v_lshlrev_b32 v44, 16, v34
    v_and_b32 v47, 0xffff0000, v36
    v_lshlrev_b32 v46, 16, v36
    v_and_b32 v49, 0xffff0000, v38
    v_lshlrev_b32 v48, 16, v38
    v_and_b32 v51, 0xffff0000, v40
    v_lshlrev_b32 v50, 16, v40
    v_add_f32 v48, 1.0, v48
    v_add_f32 v49, 1.0, v49
    v_cvt_pk_bf16_f32 v48, 0, v48
    v_cvt_pk_bf16_f32 v49, 0, v49
    v_and_b32 v5, 1, v33
    v_cmp_ne_u32 vcc, 0, v5
    s_nop 1
    v_cndmask_b32 v50, v50, v51, vcc
    v_lshrrev_b32 v5, 5, v1
    v_lshlrev_b32 v3, 11, v5
    v_and_b32 v5, 31, v1
    v_lshl_add_u32 v3, v5, 4, v3
    s_lshl_b32 s29, s7, 9
    s_lshr_b32 s30, s37, 3
    s_and_b32 s30, s30, 3
    s_lshl_b32 s30, s30, 14
    s_add_u32 s29, s29, s30
    s_add_u32 s29, s29, 397312
    v_add_u32 v3, s29, v3
    v_add_u32 v4, 8192, v3
    s_sub_u32 s29, s29, 4096
    v_and_b32 v5, 7, v1
    v_lshl_add_u32 v60, v5, 11, s29
    v_lshrrev_b32 v6, 4, v1
    s_lshl_b32 s29, s7, 6
    v_lshl_add_u32 v6, v6, 4, s29
    v_and_b32 v7, 15, v1
    v_lshlrev_b32 v7, 4, v7
    v_and_b32 v8, 15, v1
    v_lshlrev_b32 v8, 2, v8
    v_lshrrev_b32 v5, 4, v1
    v_add_u32 v8, v8, v5
    s_lshl_b32 s29, s7, 2
    v_lshl_add_u32 v8, v8, 4, s29
    v_and_b32 v9, 31, v1
    v_lshlrev_b32 v9, 4, v9
    s_lshl_b32 s29, s37, 11
    s_lshl_b32 s30, s7, 9
    s_add_u32 s29, s29, s30
    s_add_u32 s29, s29, 524288
    v_lshl_add_u32 v11, v1, 3, s29
    v_lshrrev_b32 v5, 2, v1
    v_lshlrev_b32 v54, 11, v5
    v_and_b32 v55, 0xfffffffc, v33
    v_lshl_add_u32 v54, v55, 2, v54
    v_add_u32 v54, 524288, v54
    v_add_u32 v55, 32768, v54
    v_add_u32 v56, 65536, v54
    v_add_u32 v57, 98304, v54
    v_cmp_gt_u32 vcc, 32, v1
    s_nop 1
    v_cndmask_b32 v57, v54, v57, vcc
    v_mov_b32 v58, 0
    v_mov_b32 v5, 1.0
    v_cndmask_b32 v58, v58, v5, vcc
    v_lshlrev_b32 v59, 1, v33
    v_and_b32 v5, 0x34, v1
    v_cmp_eq_u32 s[38:39], 0, v5
    v_mov_b32 v12, 0
    v_mov_b32 v13, 0
    v_mov_b32 v14, 0
    v_mov_b32 v15, 0
    v_mov_b32 v16, 0
    v_mov_b32 v17, 0
    v_mov_b32 v18, 0
    v_mov_b32 v19, 0
    s_lshr_b32 s18, s37, 3
L_ready:
    s_mov_b64 s[34:35], 0
    s_mov_b64 exec, 0
    s_nop 1
.p2align 3
L_tail:
    s_cbranch_execz L_nb_19
    s_barrier
L_nb_19:
    s_cmp_lg_u32 s7, 0
    s_cbranch_scc1 L_nocomb
    ds_read_b64 v[224:225], v237 offset:8192
    ds_read_b64 v[192:193], v236 offset:0
    ds_read_b64 v[194:195], v236 offset:512
    ds_read_b64 v[196:197], v236 offset:1024
    ds_read_b64 v[198:199], v236 offset:1536
    ds_read_b64 v[200:201], v236 offset:2048
    ds_read_b64 v[202:203], v236 offset:2560
    ds_read_b64 v[204:205], v236 offset:3072
    ds_read_b64 v[206:207], v236 offset:3584
    ds_read_b64 v[208:209], v236 offset:4096
    ds_read_b64 v[210:211], v236 offset:4608
    ds_read_b64 v[212:213], v236 offset:5120
    ds_read_b64 v[214:215], v236 offset:5632
    ds_read_b64 v[216:217], v236 offset:6144
    ds_read_b64 v[218:219], v236 offset:6656
    ds_read_b64 v[220:221], v236 offset:7168
    ds_read_b64 v[222:223], v236 offset:7680
    s_waitcnt lgkmcnt(14)
    v_max_f32_dpp v226, v224, v224 row_ror:8 row_mask:0xf bank_mask:0xf
    s_nop 1
    v_max_f32_dpp v226, v226, v226 row_ror:4 row_mask:0xf bank_mask:0xf
    s_nop 1
    v_max_f32_dpp v226, v226, v226 row_ror:2 row_mask:0xf bank_mask:0xf
    s_nop 1
    v_max_f32_dpp v226, v226, v226 row_ror:1 row_mask:0xf bank_mask:0xf
    v_sub_f32 v224, v224, v226
    v_mul_f32 v224, s26, v224
    v_exp_f32 v224, v224
    s_waitcnt lgkmcnt(0)
    v_mul_f32 v227, v224, v225
    v_mul_f32_dpp v228, v224, v192 row_newbcast:0 row_mask:0xf bank_mask:0xf
    v_mul_f32_dpp v229, v224, v193 row_newbcast:0 row_mask:0xf bank_mask:0xf
    v_mul_f32_dpp v230, v224, v194 row_newbcast:1 row_mask:0xf bank_mask:0xf
    v_mul_f32_dpp v231, v224, v195 row_newbcast:1 row_mask:0xf bank_mask:0xf
    v_add_f32_dpp v227, v227, v227 row_ror:8 row_mask:0xf bank_mask:0xf
    v_fmac_f32_dpp v228, v224, v196 row_newbcast:2 row_mask:0xf bank_mask:0xf
    v_fmac_f32_dpp v229, v224, v197 row_newbcast:2 row_mask:0xf bank_mask:0xf
    v_add_f32_dpp v227, v227, v227 row_ror:4 row_mask:0xf bank_mask:0xf
    v_fmac_f32_dpp v230, v224, v198 row_newbcast:3 row_mask:0xf bank_mask:0xf
    v_fmac_f32_dpp v231, v224, v199 row_newbcast:3 row_mask:0xf bank_mask:0xf
    v_add_f32_dpp v227, v227, v227 row_ror:2 row_mask:0xf bank_mask:0xf
    v_fmac_f32_dpp v228, v224, v200 row_newbcast:4 row_mask:0xf bank_mask:0xf
    v_fmac_f32_dpp v229, v224, v201 row_newbcast:4 row_mask:0xf bank_mask:0xf
    v_add_f32_dpp v227, v227, v227 row_ror:1 row_mask:0xf bank_mask:0xf
    v_fmac_f32_dpp v230, v224, v202 row_newbcast:5 row_mask:0xf bank_mask:0xf
    v_fmac_f32_dpp v231, v224, v203 row_newbcast:5 row_mask:0xf bank_mask:0xf
    v_fmac_f32_dpp v228, v224, v204 row_newbcast:6 row_mask:0xf bank_mask:0xf
    v_fmac_f32_dpp v229, v224, v205 row_newbcast:6 row_mask:0xf bank_mask:0xf
    v_min_u32 v226, -2, v226
    v_min_u32 v227, -2, v227
    v_fmac_f32_dpp v230, v224, v206 row_newbcast:7 row_mask:0xf bank_mask:0xf
    v_fmac_f32_dpp v231, v224, v207 row_newbcast:7 row_mask:0xf bank_mask:0xf
    v_fmac_f32_dpp v228, v224, v208 row_newbcast:8 row_mask:0xf bank_mask:0xf
    v_fmac_f32_dpp v229, v224, v209 row_newbcast:8 row_mask:0xf bank_mask:0xf
    s_and_b64 exec, exec, 1
    global_store_dwordx2 v238, v[226:227], s[66:67] offset:512 sc1
    s_mov_b64 exec, s[34:35]
    s_nop 0
    v_fmac_f32_dpp v230, v224, v210 row_newbcast:9 row_mask:0xf bank_mask:0xf
    v_fmac_f32_dpp v231, v224, v211 row_newbcast:9 row_mask:0xf bank_mask:0xf
    v_fmac_f32_dpp v228, v224, v212 row_newbcast:10 row_mask:0xf bank_mask:0xf
    v_fmac_f32_dpp v229, v224, v213 row_newbcast:10 row_mask:0xf bank_mask:0xf
    v_fmac_f32_dpp v230, v224, v214 row_newbcast:11 row_mask:0xf bank_mask:0xf
    v_fmac_f32_dpp v231, v224, v215 row_newbcast:11 row_mask:0xf bank_mask:0xf
    v_fmac_f32_dpp v228, v224, v216 row_newbcast:12 row_mask:0xf bank_mask:0xf
    v_fmac_f32_dpp v229, v224, v217 row_newbcast:12 row_mask:0xf bank_mask:0xf
    v_fmac_f32_dpp v230, v224, v218 row_newbcast:13 row_mask:0xf bank_mask:0xf
    v_fmac_f32_dpp v231, v224, v219 row_newbcast:13 row_mask:0xf bank_mask:0xf
    v_fmac_f32_dpp v228, v224, v220 row_newbcast:14 row_mask:0xf bank_mask:0xf
    v_fmac_f32_dpp v229, v224, v221 row_newbcast:14 row_mask:0xf bank_mask:0xf
    v_fmac_f32_dpp v230, v224, v222 row_newbcast:15 row_mask:0xf bank_mask:0xf
    v_fmac_f32_dpp v231, v224, v223 row_newbcast:15 row_mask:0xf bank_mask:0xf
    v_add_f32 v228, v228, v230
    v_add_f32 v229, v229, v231
    v_min_u32 v228, -2, v228
    v_min_u32 v229, -2, v229
    global_store_dwordx2 v238, v[228:229], s[66:67] sc1
L_nocomb:
    s_cmp_eq_u32 s6, 1
    s_cbranch_scc1 L_ftail
    s_cmp_lg_u32 s6, 0
    s_cbranch_scc1 L_fin
    s_mov_b32 s36, 0x40000
L_pp_20:
    global_load_dwordx2 v[112:113], v8, s[66:67] offset:512 sc1
    global_load_dwordx2 v[114:115], v8, s[66:67] offset:1536 sc1
    global_load_dwordx4 v[96:99], v3, s[66:67] offset:0 sc1
    global_load_dwordx4 v[100:103], v3, s[66:67] offset:256 sc1
    global_load_dwordx4 v[104:107], v3, s[66:67] offset:1024 sc1
    global_load_dwordx4 v[108:111], v3, s[66:67] offset:1280 sc1
    s_waitcnt vmcnt(0)
    v_max3_u32 v28, v96, v97, v98
    v_max3_u32 v29, v106, v107, v108
    v_max3_u32 v28, v28, v99, v100
    v_max3_u32 v29, v29, v109, v110
    v_max3_u32 v28, v28, v101, v102
    v_max3_u32 v29, v29, v111, v112
    v_max3_u32 v28, v28, v103, v104
    v_max3_u32 v29, v29, v113, v114
    v_max_u32 v28, v28, v105
    v_max_u32 v29, v29, v115
    v_max_u32 v28, v28, v29
    v_cmp_eq_u32 vcc, -1, v28
    s_cbranch_vccz L_ppd_21
    s_mov_b64 exec, vcc
    s_sub_u32 s36, s36, 1
    s_cbranch_scc0 L_pp_20
L_ppd_21:
    s_mov_b64 exec, s[34:35]
    s_nop 0
    v_max_f32 v20, v112, v114
    v_mov_b32 v21, v20
    s_nop 1
    v_permlane16_swap_b32 v20, v21
    v_max_f32 v20, v20, v21
    v_mov_b32 v21, v20
    s_nop 1
    v_permlane32_swap_b32 v20, v21
    v_max_f32 v20, v20, v21
    v_sub_f32 v21, v112, v20
    v_sub_f32 v22, v114, v20
    v_mul_f32 v21, s26, v21
    v_mul_f32 v22, s26, v22
    v_exp_f32 v21, v21
    v_exp_f32 v22, v22
    v_mul_f32 v23, v21, v113
    v_mul_f32 v32, v21, v96
    v_fmac_f32 v23, v22, v115
    v_mul_f32 v33, v21, v97
    v_mov_b32 v24, v23
    v_mul_f32 v34, v21, v98
    v_mul_f32 v35, v21, v99
    v_permlane16_swap_b32 v23, v24
    v_mul_f32 v36, v21, v100
    v_mul_f32 v37, v21, v101
    v_add_f32 v23, v23, v24
    v_mul_f32 v38, v21, v102
    v_mov_b32 v24, v23
    v_mul_f32 v39, v21, v103
    v_fmac_f32 v32, v22, v104
    v_permlane32_swap_b32 v23, v24
    v_fmac_f32 v36, v22, v108
    v_fmac_f32 v33, v22, v105
    v_add_f32 v23, v23, v24
    v_fmac_f32 v37, v22, v109
    v_fmac_f32 v34, v22, v106
    v_rcp_f32 v23, v23
    v_fmac_f32 v38, v22, v110
    v_fmac_f32 v35, v22, v107
    v_fmac_f32 v39, v22, v111
    v_permlane32_swap_b32 v32, v36
    v_permlane32_swap_b32 v33, v37
    v_permlane32_swap_b32 v34, v38
    v_permlane32_swap_b32 v35, v39
    v_add_f32 v32, v32, v36
    v_add_f32 v33, v33, v37
    v_add_f32 v34, v34, v38
    v_add_f32 v35, v35, v39
    s_nop 0
    v_permlane16_swap_b32 v32, v34
    v_permlane16_swap_b32 v33, v35
    v_add_f32 v32, v32, v34
    v_add_f32 v33, v33, v35
    v_mul_f32 v32, v32, v23
    v_mul_f32 v33, v33, v23
    v_cvt_pk_bf16_f32 v24, v32, v33
    s_nop 1
    v_dot2c_f32_bf16_dpp v12, v24, v120 row_newbcast:0 row_mask:0xf bank_mask:0xf
    v_dot2c_f32_bf16_dpp v13, v24, v122 row_newbcast:0 row_mask:0xf bank_mask:0xf
    v_dot2c_f32_bf16_dpp v14, v24, v121 row_newbcast:0 row_mask:0xf bank_mask:0xf
    v_dot2c_f32_bf16_dpp v15, v24, v123 row_newbcast:0 row_mask:0xf bank_mask:0xf
    v_dot2c_f32_bf16_dpp v12, v24, v124 row_newbcast:1 row_mask:0xf bank_mask:0xf
    v_dot2c_f32_bf16_dpp v13, v24, v126 row_newbcast:1 row_mask:0xf bank_mask:0xf
    v_dot2c_f32_bf16_dpp v14, v24, v125 row_newbcast:1 row_mask:0xf bank_mask:0xf
    v_dot2c_f32_bf16_dpp v15, v24, v127 row_newbcast:1 row_mask:0xf bank_mask:0xf
    v_dot2c_f32_bf16_dpp v12, v24, v128 row_newbcast:2 row_mask:0xf bank_mask:0xf
    v_dot2c_f32_bf16_dpp v13, v24, v130 row_newbcast:2 row_mask:0xf bank_mask:0xf
    v_dot2c_f32_bf16_dpp v14, v24, v129 row_newbcast:2 row_mask:0xf bank_mask:0xf
    v_dot2c_f32_bf16_dpp v15, v24, v131 row_newbcast:2 row_mask:0xf bank_mask:0xf
    v_dot2c_f32_bf16_dpp v12, v24, v132 row_newbcast:3 row_mask:0xf bank_mask:0xf
    v_dot2c_f32_bf16_dpp v13, v24, v134 row_newbcast:3 row_mask:0xf bank_mask:0xf
    v_dot2c_f32_bf16_dpp v14, v24, v133 row_newbcast:3 row_mask:0xf bank_mask:0xf
    v_dot2c_f32_bf16_dpp v15, v24, v135 row_newbcast:3 row_mask:0xf bank_mask:0xf
    v_dot2c_f32_bf16_dpp v12, v24, v136 row_newbcast:4 row_mask:0xf bank_mask:0xf
    v_dot2c_f32_bf16_dpp v13, v24, v138 row_newbcast:4 row_mask:0xf bank_mask:0xf
    v_dot2c_f32_bf16_dpp v14, v24, v137 row_newbcast:4 row_mask:0xf bank_mask:0xf
    v_dot2c_f32_bf16_dpp v15, v24, v139 row_newbcast:4 row_mask:0xf bank_mask:0xf
    v_dot2c_f32_bf16_dpp v12, v24, v140 row_newbcast:5 row_mask:0xf bank_mask:0xf
    v_dot2c_f32_bf16_dpp v13, v24, v142 row_newbcast:5 row_mask:0xf bank_mask:0xf
    v_dot2c_f32_bf16_dpp v14, v24, v141 row_newbcast:5 row_mask:0xf bank_mask:0xf
    v_dot2c_f32_bf16_dpp v15, v24, v143 row_newbcast:5 row_mask:0xf bank_mask:0xf
    v_dot2c_f32_bf16_dpp v12, v24, v144 row_newbcast:6 row_mask:0xf bank_mask:0xf
    v_dot2c_f32_bf16_dpp v13, v24, v146 row_newbcast:6 row_mask:0xf bank_mask:0xf
    v_dot2c_f32_bf16_dpp v14, v24, v145 row_newbcast:6 row_mask:0xf bank_mask:0xf
    v_dot2c_f32_bf16_dpp v15, v24, v147 row_newbcast:6 row_mask:0xf bank_mask:0xf
    v_dot2c_f32_bf16_dpp v12, v24, v148 row_newbcast:7 row_mask:0xf bank_mask:0xf
    v_dot2c_f32_bf16_dpp v13, v24, v150 row_newbcast:7 row_mask:0xf bank_mask:0xf
    v_dot2c_f32_bf16_dpp v14, v24, v149 row_newbcast:7 row_mask:0xf bank_mask:0xf
    v_dot2c_f32_bf16_dpp v15, v24, v151 row_newbcast:7 row_mask:0xf bank_mask:0xf
    v_dot2c_f32_bf16_dpp v12, v24, v152 row_newbcast:8 row_mask:0xf bank_mask:0xf
    v_dot2c_f32_bf16_dpp v13, v24, v154 row_newbcast:8 row_mask:0xf bank_mask:0xf
    v_dot2c_f32_bf16_dpp v14, v24, v153 row_newbcast:8 row_mask:0xf bank_mask:0xf
    v_dot2c_f32_bf16_dpp v15, v24, v155 row_newbcast:8 row_mask:0xf bank_mask:0xf
    v_dot2c_f32_bf16_dpp v12, v24, v156 row_newbcast:9 row_mask:0xf bank_mask:0xf
    v_dot2c_f32_bf16_dpp v13, v24, v158 row_newbcast:9 row_mask:0xf bank_mask:0xf
    v_dot2c_f32_bf16_dpp v14, v24, v157 row_newbcast:9 row_mask:0xf bank_mask:0xf
    v_dot2c_f32_bf16_dpp v15, v24, v159 row_newbcast:9 row_mask:0xf bank_mask:0xf
    v_dot2c_f32_bf16_dpp v12, v24, v160 row_newbcast:10 row_mask:0xf bank_mask:0xf
    v_dot2c_f32_bf16_dpp v13, v24, v162 row_newbcast:10 row_mask:0xf bank_mask:0xf
    v_dot2c_f32_bf16_dpp v14, v24, v161 row_newbcast:10 row_mask:0xf bank_mask:0xf
    v_dot2c_f32_bf16_dpp v15, v24, v163 row_newbcast:10 row_mask:0xf bank_mask:0xf
    v_dot2c_f32_bf16_dpp v12, v24, v164 row_newbcast:11 row_mask:0xf bank_mask:0xf
    v_dot2c_f32_bf16_dpp v13, v24, v166 row_newbcast:11 row_mask:0xf bank_mask:0xf
    v_dot2c_f32_bf16_dpp v14, v24, v165 row_newbcast:11 row_mask:0xf bank_mask:0xf
    v_dot2c_f32_bf16_dpp v15, v24, v167 row_newbcast:11 row_mask:0xf bank_mask:0xf
    v_dot2c_f32_bf16_dpp v12, v24, v168 row_newbcast:12 row_mask:0xf bank_mask:0xf
    v_dot2c_f32_bf16_dpp v13, v24, v170 row_newbcast:12 row_mask:0xf bank_mask:0xf
    v_dot2c_f32_bf16_dpp v14, v24, v169 row_newbcast:12 row_mask:0xf bank_mask:0xf
    v_dot2c_f32_bf16_dpp v15, v24, v171 row_newbcast:12 row_mask:0xf bank_mask:0xf
    v_dot2c_f32_bf16_dpp v12, v24, v172 row_newbcast:13 row_mask:0xf bank_mask:0xf
    v_dot2c_f32_bf16_dpp v13, v24, v174 row_newbcast:13 row_mask:0xf bank_mask:0xf
    v_dot2c_f32_bf16_dpp v14, v24, v173 row_newbcast:13 row_mask:0xf bank_mask:0xf
    v_dot2c_f32_bf16_dpp v15, v24, v175 row_newbcast:13 row_mask:0xf bank_mask:0xf
    v_dot2c_f32_bf16_dpp v12, v24, v176 row_newbcast:14 row_mask:0xf bank_mask:0xf
    v_dot2c_f32_bf16_dpp v13, v24, v178 row_newbcast:14 row_mask:0xf bank_mask:0xf
    v_dot2c_f32_bf16_dpp v14, v24, v177 row_newbcast:14 row_mask:0xf bank_mask:0xf
    v_dot2c_f32_bf16_dpp v15, v24, v179 row_newbcast:14 row_mask:0xf bank_mask:0xf
    v_dot2c_f32_bf16_dpp v12, v24, v180 row_newbcast:15 row_mask:0xf bank_mask:0xf
    v_dot2c_f32_bf16_dpp v13, v24, v182 row_newbcast:15 row_mask:0xf bank_mask:0xf
    v_dot2c_f32_bf16_dpp v14, v24, v181 row_newbcast:15 row_mask:0xf bank_mask:0xf
    v_dot2c_f32_bf16_dpp v15, v24, v183 row_newbcast:15 row_mask:0xf bank_mask:0xf
    s_nop 1
    v_permlane32_swap_b32 v12, v14
    v_permlane32_swap_b32 v13, v15
    v_add_f32 v12, v12, v14
    v_add_f32 v13, v13, v15
    s_nop 1
    v_permlane16_swap_b32 v12, v13
    v_add_f32 v12, v12, v13
    ds_write_b32 v9, v12 offset:8704
    s_waitcnt lgkmcnt(0)
    s_cbranch_execz L_nb_22
    s_barrier
L_nb_22:
    ds_read_b128 v[20:23], v10 offset:8704
    s_waitcnt lgkmcnt(0)
    v_add_f32 v20, v20, v21
    v_add_f32 v22, v22, v23
    v_add_f32 v20, v20, v22
    v_min_u32 v20, -2, v20
    global_store_dword v11, v20, s[66:67] sc1
    s_branch L_fin
L_ftail:
    s_mov_b32 s36, 0x40000
    s_and_b64 exec, exec, 255
L_pl_25:
    global_load_dword v28, v60, s[66:67] sc1
    s_waitcnt vmcnt(0)
    v_cmp_eq_u32 vcc, -1, v28
    s_nop 0
    s_bcnt1_i32_b64 s29, vcc
    s_cmp_le_u32 s29, 2
    s_cbranch_scc1 L_plg_26
    s_sleep 2
    s_sub_u32 s36, s36, 1
    s_cbranch_scc0 L_pl_25
L_plg_26:
    s_mov_b64 exec, s[34:35]
    s_mov_b32 s36, 0x40000
L_pp_23:
    global_load_dwordx4 v[168:171], v3, s[66:67] offset:-4096 sc1
    global_load_dwordx4 v[172:175], v3, s[66:67] offset:0 sc1
    global_load_dwordx4 v[176:179], v4, s[66:67] offset:-4096 sc1
    global_load_dwordx4 v[180:183], v4, s[66:67] offset:0 sc1
    s_waitcnt vmcnt(0)
    v_max3_u32 v28, v168, v169, v170
    v_max3_u32 v29, v176, v177, v178
    v_max3_u32 v28, v28, v171, v172
    v_max3_u32 v29, v29, v179, v180
    v_max3_u32 v28, v28, v173, v174
    v_max3_u32 v29, v29, v181, v182
    v_max_u32 v28, v28, v175
    v_max_u32 v29, v29, v183
    v_max_u32 v28, v28, v29
    v_cmp_eq_u32 vcc, -1, v28
    s_cbranch_vccz L_ppd_24
    s_mov_b64 exec, vcc
    s_sub_u32 s36, s36, 1
    s_cbranch_scc0 L_pp_23
L_ppd_24:
    s_mov_b64 exec, s[34:35]
    s_nop 0
    v_add_f32 v160, v168, v176
    v_add_f32 v161, v169, v177
    v_add_f32 v162, v170, v178
    v_add_f32 v163, v171, v179
    v_add_f32 v164, v172, v180
    v_add_f32 v165, v173, v181
    v_add_f32 v166, v174, v182
    v_add_f32 v167, v175, v183
    v_add_f32 v160, v160, v164
    v_add_f32 v161, v161, v165
    v_add_f32 v162, v162, v166
    v_add_f32 v163, v163, v167
    s_nop 0
    v_permlane32_swap_b32 v160, v162
    v_permlane32_swap_b32 v161, v163
    v_add_f32 v160, v160, v162
    v_add_f32 v161, v161, v163
    v_cvt_pk_bf16_f32 v160, 0, v160
    v_cvt_pk_bf16_f32 v161, 0, v161
    v_mul_f32 v20, v160, v44
    v_mul_f32 v21, v161, v45
    v_cvt_pk_bf16_f32 v20, 0, v20
    v_cvt_pk_bf16_f32 v21, 0, v21
    v_add_f32 v20, v42, v20
    v_add_f32 v21, v43, v21
    v_cvt_pk_bf16_f32 v22, v20, v21
    v_cvt_pk_bf16_f32 v20, 0, v20
    v_cvt_pk_bf16_f32 v21, 0, v21
    s_nop 0
    v_mov_b32_dpp v24, v20 row_newbcast:0 row_mask:0xf bank_mask:0xf
    ds_write_b32 v53, v22 offset:10752
    v_sub_f32 v22, v20, v24
    v_sub_f32 v23, v21, v24
    v_add_f32 v25, v22, v23
    v_mul_f32 v26, v22, v22
    v_fmac_f32 v26, v23, v23
    v_add_f32_dpp v25, v25, v25 row_ror:8 row_mask:0xf bank_mask:0xf
    s_nop 0
    v_add_f32_dpp v26, v26, v26 row_ror:8 row_mask:0xf bank_mask:0xf
    v_add_f32_dpp v25, v25, v25 row_ror:4 row_mask:0xf bank_mask:0xf
    s_nop 0
    v_add_f32_dpp v26, v26, v26 row_ror:4 row_mask:0xf bank_mask:0xf
    v_add_f32_dpp v25, v25, v25 row_ror:2 row_mask:0xf bank_mask:0xf
    s_nop 0
    v_add_f32_dpp v26, v26, v26 row_ror:2 row_mask:0xf bank_mask:0xf
    v_add_f32_dpp v25, v25, v25 row_ror:1 row_mask:0xf bank_mask:0xf
    s_nop 0
    v_add_f32_dpp v26, v26, v26 row_ror:1 row_mask:0xf bank_mask:0xf
    ds_write_b128 v6, v[24:27] offset:9216
    s_waitcnt lgkmcnt(0)
    s_cbranch_execz L_nb_27
    s_barrier
L_nb_27:
    ds_read_b128 v[24:27], v7 offset:9216
    ds_read_u16 v51, v59 offset:10752
    s_waitcnt lgkmcnt(1)
    s_mov_b32 s29, 0x42000000
    v_fma_f32 v22, v24, s29, v25
    s_nop 1
    v_add_f32_dpp v22, v22, v22 row_ror:8 row_mask:0xf bank_mask:0xf
    s_nop 1
    v_add_f32_dpp v22, v22, v22 row_ror:4 row_mask:0xf bank_mask:0xf
    s_nop 1
    v_add_f32_dpp v22, v22, v22 row_ror:2 row_mask:0xf bank_mask:0xf
    s_nop 1
    v_add_f32_dpp v22, v22, v22 row_ror:1 row_mask:0xf bank_mask:0xf
    v_mul_f32 v22, 0x3b000000, v22
    v_sub_f32 v23, v22, v24
    v_cvt_pk_bf16_f32 v22, 0, v22
    v_mul_f32 v27, s29, v23
    v_sub_f32 v20, v20, v22
    v_fmac_f32 v27, -2.0, v25
    v_sub_f32 v21, v21, v22
    v_fmac_f32 v26, v23, v27
    v_cvt_pk_bf16_f32 v20, 0, v20
    v_cvt_pk_bf16_f32 v21, 0, v21
    v_add_f32_dpp v26, v26, v26 row_ror:8 row_mask:0xf bank_mask:0xf
    s_nop 1
    v_add_f32_dpp v26, v26, v26 row_ror:4 row_mask:0xf bank_mask:0xf
    s_nop 1
    v_add_f32_dpp v26, v26, v26 row_ror:2 row_mask:0xf bank_mask:0xf
    s_nop 1
    v_add_f32_dpp v26, v26, v26 row_ror:1 row_mask:0xf bank_mask:0xf
    v_mul_f32 v26, 0x3b000000, v26
    v_cvt_pk_bf16_f32 v26, 0, v26
    v_add_f32 v26, 0x3727c5ac, v26
    v_cvt_pk_bf16_f32 v26, 0, v26
    v_sqrt_f32 v26, v26
    s_nop 0
    v_cvt_pk_bf16_f32 v26, 0, v26
    v_rcp_f32 v27, v26
    s_nop 0
    v_mul_f32 v22, v20, v27
    v_mul_f32 v23, v21, v27
    v_fma_f32 v20, -v22, v26, v20
    v_fma_f32 v21, -v23, v26, v21
    v_fma_f32 v20, v20, v27, v22
    v_fma_f32 v21, v21, v27, v23
    v_cvt_pk_bf16_f32 v20, 0, v20
    v_cvt_pk_bf16_f32 v21, 0, v21
    v_mul_f32 v20, v20, v48
    v_mul_f32 v21, v21, v49
    v_cvt_pk_bf16_f32 v20, 0, v20
    v_cvt_pk_bf16_f32 v21, 0, v21
    v_add_f32 v20, v20, v46
    v_add_f32 v21, v21, v47
    v_cvt_pk_bf16_f32 v23, v20, v21
    s_nop 1
    v_dot2c_f32_bf16_dpp v12, v23, v64 row_newbcast:0 row_mask:0xf bank_mask:0xf
    v_dot2c_f32_bf16_dpp v13, v23, v66 row_newbcast:0 row_mask:0xf bank_mask:0xf
    v_dot2c_f32_bf16_dpp v14, v23, v65 row_newbcast:0 row_mask:0xf bank_mask:0xf
    v_dot2c_f32_bf16_dpp v15, v23, v67 row_newbcast:0 row_mask:0xf bank_mask:0xf
    v_dot2c_f32_bf16_dpp v12, v23, v68 row_newbcast:1 row_mask:0xf bank_mask:0xf
    v_dot2c_f32_bf16_dpp v13, v23, v70 row_newbcast:1 row_mask:0xf bank_mask:0xf
    v_dot2c_f32_bf16_dpp v14, v23, v69 row_newbcast:1 row_mask:0xf bank_mask:0xf
    v_dot2c_f32_bf16_dpp v15, v23, v71 row_newbcast:1 row_mask:0xf bank_mask:0xf
    v_dot2c_f32_bf16_dpp v12, v23, v72 row_newbcast:2 row_mask:0xf bank_mask:0xf
    v_dot2c_f32_bf16_dpp v13, v23, v74 row_newbcast:2 row_mask:0xf bank_mask:0xf
    v_dot2c_f32_bf16_dpp v14, v23, v73 row_newbcast:2 row_mask:0xf bank_mask:0xf
    v_dot2c_f32_bf16_dpp v15, v23, v75 row_newbcast:2 row_mask:0xf bank_mask:0xf
    v_dot2c_f32_bf16_dpp v12, v23, v76 row_newbcast:3 row_mask:0xf bank_mask:0xf
    v_dot2c_f32_bf16_dpp v13, v23, v78 row_newbcast:3 row_mask:0xf bank_mask:0xf
    v_dot2c_f32_bf16_dpp v14, v23, v77 row_newbcast:3 row_mask:0xf bank_mask:0xf
    v_dot2c_f32_bf16_dpp v15, v23, v79 row_newbcast:3 row_mask:0xf bank_mask:0xf
    v_dot2c_f32_bf16_dpp v12, v23, v80 row_newbcast:4 row_mask:0xf bank_mask:0xf
    v_dot2c_f32_bf16_dpp v13, v23, v82 row_newbcast:4 row_mask:0xf bank_mask:0xf
    v_dot2c_f32_bf16_dpp v14, v23, v81 row_newbcast:4 row_mask:0xf bank_mask:0xf
    v_dot2c_f32_bf16_dpp v15, v23, v83 row_newbcast:4 row_mask:0xf bank_mask:0xf
    v_dot2c_f32_bf16_dpp v12, v23, v84 row_newbcast:5 row_mask:0xf bank_mask:0xf
    v_dot2c_f32_bf16_dpp v13, v23, v86 row_newbcast:5 row_mask:0xf bank_mask:0xf
    v_dot2c_f32_bf16_dpp v14, v23, v85 row_newbcast:5 row_mask:0xf bank_mask:0xf
    v_dot2c_f32_bf16_dpp v15, v23, v87 row_newbcast:5 row_mask:0xf bank_mask:0xf
    v_dot2c_f32_bf16_dpp v12, v23, v88 row_newbcast:6 row_mask:0xf bank_mask:0xf
    v_dot2c_f32_bf16_dpp v13, v23, v90 row_newbcast:6 row_mask:0xf bank_mask:0xf
    v_dot2c_f32_bf16_dpp v14, v23, v89 row_newbcast:6 row_mask:0xf bank_mask:0xf
    v_dot2c_f32_bf16_dpp v15, v23, v91 row_newbcast:6 row_mask:0xf bank_mask:0xf
    v_dot2c_f32_bf16_dpp v12, v23, v92 row_newbcast:7 row_mask:0xf bank_mask:0xf
    v_dot2c_f32_bf16_dpp v13, v23, v94 row_newbcast:7 row_mask:0xf bank_mask:0xf
    v_dot2c_f32_bf16_dpp v14, v23, v93 row_newbcast:7 row_mask:0xf bank_mask:0xf
    v_dot2c_f32_bf16_dpp v15, v23, v95 row_newbcast:7 row_mask:0xf bank_mask:0xf
    v_dot2c_f32_bf16_dpp v12, v23, v96 row_newbcast:8 row_mask:0xf bank_mask:0xf
    v_dot2c_f32_bf16_dpp v13, v23, v98 row_newbcast:8 row_mask:0xf bank_mask:0xf
    v_dot2c_f32_bf16_dpp v14, v23, v97 row_newbcast:8 row_mask:0xf bank_mask:0xf
    v_dot2c_f32_bf16_dpp v15, v23, v99 row_newbcast:8 row_mask:0xf bank_mask:0xf
    v_dot2c_f32_bf16_dpp v12, v23, v100 row_newbcast:9 row_mask:0xf bank_mask:0xf
    v_dot2c_f32_bf16_dpp v13, v23, v102 row_newbcast:9 row_mask:0xf bank_mask:0xf
    v_dot2c_f32_bf16_dpp v14, v23, v101 row_newbcast:9 row_mask:0xf bank_mask:0xf
    v_dot2c_f32_bf16_dpp v15, v23, v103 row_newbcast:9 row_mask:0xf bank_mask:0xf
    v_dot2c_f32_bf16_dpp v12, v23, v104 row_newbcast:10 row_mask:0xf bank_mask:0xf
    v_dot2c_f32_bf16_dpp v13, v23, v106 row_newbcast:10 row_mask:0xf bank_mask:0xf
    v_dot2c_f32_bf16_dpp v14, v23, v105 row_newbcast:10 row_mask:0xf bank_mask:0xf
    v_dot2c_f32_bf16_dpp v15, v23, v107 row_newbcast:10 row_mask:0xf bank_mask:0xf
    v_dot2c_f32_bf16_dpp v12, v23, v108 row_newbcast:11 row_mask:0xf bank_mask:0xf
    v_dot2c_f32_bf16_dpp v13, v23, v110 row_newbcast:11 row_mask:0xf bank_mask:0xf
    v_dot2c_f32_bf16_dpp v14, v23, v109 row_newbcast:11 row_mask:0xf bank_mask:0xf
    v_dot2c_f32_bf16_dpp v15, v23, v111 row_newbcast:11 row_mask:0xf bank_mask:0xf
    v_dot2c_f32_bf16_dpp v12, v23, v112 row_newbcast:12 row_mask:0xf bank_mask:0xf
    v_dot2c_f32_bf16_dpp v13, v23, v114 row_newbcast:12 row_mask:0xf bank_mask:0xf
    v_dot2c_f32_bf16_dpp v14, v23, v113 row_newbcast:12 row_mask:0xf bank_mask:0xf
    v_dot2c_f32_bf16_dpp v15, v23, v115 row_newbcast:12 row_mask:0xf bank_mask:0xf
    v_dot2c_f32_bf16_dpp v12, v23, v116 row_newbcast:13 row_mask:0xf bank_mask:0xf
    v_dot2c_f32_bf16_dpp v13, v23, v118 row_newbcast:13 row_mask:0xf bank_mask:0xf
    v_dot2c_f32_bf16_dpp v14, v23, v117 row_newbcast:13 row_mask:0xf bank_mask:0xf
    v_dot2c_f32_bf16_dpp v15, v23, v119 row_newbcast:13 row_mask:0xf bank_mask:0xf
    v_dot2c_f32_bf16_dpp v12, v23, v120 row_newbcast:14 row_mask:0xf bank_mask:0xf
    v_dot2c_f32_bf16_dpp v13, v23, v122 row_newbcast:14 row_mask:0xf bank_mask:0xf
    v_dot2c_f32_bf16_dpp v14, v23, v121 row_newbcast:14 row_mask:0xf bank_mask:0xf
    v_dot2c_f32_bf16_dpp v15, v23, v123 row_newbcast:14 row_mask:0xf bank_mask:0xf
    v_dot2c_f32_bf16_dpp v12, v23, v124 row_newbcast:15 row_mask:0xf bank_mask:0xf
    v_dot2c_f32_bf16_dpp v13, v23, v126 row_newbcast:15 row_mask:0xf bank_mask:0xf
    v_dot2c_f32_bf16_dpp v14, v23, v125 row_newbcast:15 row_mask:0xf bank_mask:0xf
    v_dot2c_f32_bf16_dpp v15, v23, v127 row_newbcast:15 row_mask:0xf bank_mask:0xf
    s_nop 1
    v_permlane32_swap_b32 v12, v14
    v_permlane32_swap_b32 v13, v15
    v_add_f32 v12, v12, v14
    v_add_f32 v13, v13, v15
    s_nop 1
    v_permlane16_swap_b32 v12, v13
    v_add_f32 v12, v12, v13
    ds_write_b32 v8, v12 offset:9728
    s_waitcnt lgkmcnt(0)
    s_cbranch_execz L_nb_28
    s_barrier
L_nb_28:
    ds_read_b128 v[20:23], v9 offset:9728
    ds_read_b128 v[24:27], v9 offset:10240
    s_waitcnt lgkmcnt(0)
    v_add_f32 v20, v20, v21
    v_add_f32 v22, v22, v23
    v_add_f32 v24, v24, v25
    v_add_f32 v26, v26, v27
    v_add_f32 v20, v20, v22
    v_add_f32 v24, v24, v26
    v_cvt_pk_bf16_f32 v20, 0, v20
    v_cvt_pk_bf16_f32 v24, 0, v24
    v_mul_f32 v21, 0xbfb8aa3b, v20
    v_exp_f32 v21, v21
    s_nop 0
    v_add_f32 v21, 1.0, v21
    v_rcp_f32 v21, v21
    s_nop 0
    v_mul_f32 v20, v20, v21
    v_cvt_pk_bf16_f32 v20, 0, v20
    v_mul_f32 v20, v20, v24
    s_nop 1
    v_mov_b32_dpp v21, v20 quad_perm:[1,1,3,3] row_mask:0xf bank_mask:0xf
    v_cvt_pk_bf16_f32 v22, v20, v21
    v_cvt_pk_bf16_f32 v23, v20, v21
    s_nop 1
    v_permlane16_swap_b32 v22, v23
    s_nop 1
    v_dot2c_f32_bf16_dpp v16, v22, v128 row_newbcast:0 row_mask:0xf bank_mask:0xf
    v_dot2c_f32_bf16_dpp v17, v22, v129 row_newbcast:0 row_mask:0xf bank_mask:0xf
    v_dot2c_f32_bf16_dpp v18, v23, v144 row_newbcast:0 row_mask:0xf bank_mask:0xf
    v_dot2c_f32_bf16_dpp v19, v23, v145 row_newbcast:0 row_mask:0xf bank_mask:0xf
    v_dot2c_f32_bf16_dpp v16, v22, v130 row_newbcast:2 row_mask:0xf bank_mask:0xf
    v_dot2c_f32_bf16_dpp v17, v22, v131 row_newbcast:2 row_mask:0xf bank_mask:0xf
    v_dot2c_f32_bf16_dpp v18, v23, v146 row_newbcast:2 row_mask:0xf bank_mask:0xf
    v_dot2c_f32_bf16_dpp v19, v23, v147 row_newbcast:2 row_mask:0xf bank_mask:0xf
    v_dot2c_f32_bf16_dpp v16, v22, v132 row_newbcast:4 row_mask:0xf bank_mask:0xf
    v_dot2c_f32_bf16_dpp v17, v22, v133 row_newbcast:4 row_mask:0xf bank_mask:0xf
    v_dot2c_f32_bf16_dpp v18, v23, v148 row_newbcast:4 row_mask:0xf bank_mask:0xf
    v_dot2c_f32_bf16_dpp v19, v23, v149 row_newbcast:4 row_mask:0xf bank_mask:0xf
    v_dot2c_f32_bf16_dpp v16, v22, v134 row_newbcast:6 row_mask:0xf bank_mask:0xf
    v_dot2c_f32_bf16_dpp v17, v22, v135 row_newbcast:6 row_mask:0xf bank_mask:0xf
    v_dot2c_f32_bf16_dpp v18, v23, v150 row_newbcast:6 row_mask:0xf bank_mask:0xf
    v_dot2c_f32_bf16_dpp v19, v23, v151 row_newbcast:6 row_mask:0xf bank_mask:0xf
    v_dot2c_f32_bf16_dpp v16, v22, v136 row_newbcast:8 row_mask:0xf bank_mask:0xf
    v_dot2c_f32_bf16_dpp v17, v22, v137 row_newbcast:8 row_mask:0xf bank_mask:0xf
    v_dot2c_f32_bf16_dpp v18, v23, v152 row_newbcast:8 row_mask:0xf bank_mask:0xf
    v_dot2c_f32_bf16_dpp v19, v23, v153 row_newbcast:8 row_mask:0xf bank_mask:0xf
    v_dot2c_f32_bf16_dpp v16, v22, v138 row_newbcast:10 row_mask:0xf bank_mask:0xf
    v_dot2c_f32_bf16_dpp v17, v22, v139 row_newbcast:10 row_mask:0xf bank_mask:0xf
    v_dot2c_f32_bf16_dpp v18, v23, v154 row_newbcast:10 row_mask:0xf bank_mask:0xf
    v_dot2c_f32_bf16_dpp v19, v23, v155 row_newbcast:10 row_mask:0xf bank_mask:0xf
    v_dot2c_f32_bf16_dpp v16, v22, v140 row_newbcast:12 row_mask:0xf bank_mask:0xf
    v_dot2c_f32_bf16_dpp v17, v22, v141 row_newbcast:12 row_mask:0xf bank_mask:0xf
    v_dot2c_f32_bf16_dpp v18, v23, v156 row_newbcast:12 row_mask:0xf bank_mask:0xf
    v_dot2c_f32_bf16_dpp v19, v23, v157 row_newbcast:12 row_mask:0xf bank_mask:0xf
    v_dot2c_f32_bf16_dpp v16, v22, v142 row_newbcast:14 row_mask:0xf bank_mask:0xf
    v_dot2c_f32_bf16_dpp v17, v22, v143 row_newbcast:14 row_mask:0xf bank_mask:0xf
    v_dot2c_f32_bf16_dpp v18, v23, v158 row_newbcast:14 row_mask:0xf bank_mask:0xf
    v_dot2c_f32_bf16_dpp v19, v23, v159 row_newbcast:14 row_mask:0xf bank_mask:0xf
    s_nop 1
    v_add_f32 v16, v16, v18
    v_add_f32 v17, v17, v19
    v_min_u32 v16, -2, v16
    v_min_u32 v17, -2, v17
    global_store_dwordx2 v11, v[16:17], s[66:67] sc1
    s_cmp_lg_u32 s18, s7
    s_cbranch_scc1 L_fin
    v_lshlrev_b32 v52, 16, v51
    s_waitcnt vmcnt(0)
    s_mov_b32 s36, 0x40000
L_pp_29:
    global_load_dwordx4 v[168:171], v54, s[66:67] sc1
    global_load_dwordx4 v[172:175], v55, s[66:67] sc1
    global_load_dwordx4 v[176:179], v56, s[66:67] sc1
    global_load_dwordx4 v[180:183], v57, s[66:67] sc1
    s_waitcnt vmcnt(0)
    v_max3_u32 v28, v168, v169, v170
    v_max3_u32 v29, v176, v177, v178
    v_max3_u32 v28, v28, v171, v172
    v_max3_u32 v29, v29, v179, v180
    v_max3_u32 v28, v28, v173, v174
    v_max3_u32 v29, v29, v181, v182
    v_max_u32 v28, v28, v175
    v_max_u32 v29, v29, v183
    v_max_u32 v28, v28, v29
    v_cmp_eq_u32 vcc, -1, v28
    s_cbranch_vccz L_ppd_30
    s_mov_b64 exec, vcc
    s_sub_u32 s36, s36, 1
    s_cbranch_scc0 L_pp_29
L_ppd_30:
    s_mov_b64 exec, s[34:35]
    s_nop 0
    v_add_f32 v160, v168, v172
    v_add_f32 v161, v169, v173
    v_add_f32 v162, v170, v174
    v_add_f32 v163, v171, v175
    v_fma_f32 v164, v180, v58, v176
    v_fma_f32 v165, v181, v58, v177
    v_fma_f32 v166, v182, v58, v178
    v_fma_f32 v167, v183, v58, v179
    v_add_f32 v160, v160, v164
    v_add_f32 v161, v161, v165
    v_add_f32 v162, v162, v166
    v_add_f32 v163, v163, v167
    v_add_f32_dpp v160, v160, v160 row_ror:8 row_mask:0xf bank_mask:0x3
    v_add_f32_dpp v161, v161, v161 row_ror:8 row_mask:0xf bank_mask:0x3
    s_nop 0
    v_add_f32_dpp v160, v162, v162 row_ror:8 row_mask:0xf bank_mask:0xc
    v_add_f32_dpp v161, v163, v163 row_ror:8 row_mask:0xf bank_mask:0xc
    s_nop 0
    v_add_f32_dpp v160, v160, v160 row_shl:4 row_mask:0xf bank_mask:0x5
    s_nop 1
    v_add_f32_dpp v160, v161, v161 row_shr:4 row_mask:0xf bank_mask:0xa
    v_mov_b32 v161, v160
    s_nop 1
    v_permlane16_swap_b32 v160, v161
    v_add_f32 v160, v160, v161
    v_mov_b32 v161, v160
    s_nop 1
    v_permlane32_swap_b32 v160, v161
    v_add_f32 v160, v160, v161
    v_cvt_pk_bf16_f32 v160, 0, v160
    v_mul_f32 v20, v160, v50
    v_cvt_pk_bf16_f32 v20, 0, v20
    v_add_f32 v20, v20, v52
    s_nop 1
    v_mov_b32_dpp v21, v20 row_shl:4 row_mask:0xf bank_mask:0xf
    v_cvt_pk_bf16_f32 v20, v20, v21
    s_and_b64 exec, exec, s[38:39]
    global_store_dword v59, v20, s[62:63]
    s_cmp_lg_u32 s37, 0
    s_cbranch_scc1 L_fin
    s_and_b64 exec, exec, 1
    v_mov_b32 v20, s22
    global_store_dword v7, v20, s[66:67] offset:0
L_fin:
    s_cbranch_execnz L_end
    s_mov_b64 s[34:35], -1
    s_mov_b64 exec, -1
    s_branch L_tail
L_end:
    s_endpgm
.fill 4096, 4, 0xbf810000
.section .rodata,"a"
.p2align 6
.amdhsa_kernel adaLN_cond__mha_block_cached__glu_gated_swiglu__decode_kernel
  .amdhsa_next_free_vgpr 256
  .amdhsa_next_free_sgpr 100
  .amdhsa_accum_offset 256
  .amdhsa_group_segment_fixed_size 0
  .amdhsa_kernarg_size 112
  .amdhsa_user_sgpr_count 2
  .amdhsa_user_sgpr_kernarg_segment_ptr 1
  .amdhsa_system_sgpr_workgroup_id_x 1
  .amdhsa_float_denorm_mode_32 3
.end_amdhsa_kernel
```
